```python
import torch

def _softmax(x, axis=-1):
    return torch.softmax(x, dim=axis)
def _gelu(x):
    return torch.nn.functional.gelu(x, approximate="tanh")
def _silu(x):
    return torch.nn.functional.silu(x)
def _sigmoid(x):
    return torch.sigmoid(x)
def _layernorm(x, axis=-1, eps=1e-5):
    m = x.mean(dim=axis, keepdim=True)
    v = x.var(dim=axis, keepdim=True, unbiased=False)
    return (x - m) / torch.sqrt(v + eps)
def _scatter_add(tgt, idx, src, axis=0):
    return tgt.clone().index_add_(axis, idx, src)
def _segment_sum(src, seg, n):
    out = torch.zeros((n,) + src.shape[1:], dtype=src.dtype)
    return out.index_add_(0, seg, src)
def _pad(x, pw):
    flat = tuple(v for pair in reversed(pw) for v in pair)
    return torch.nn.functional.pad(x, flat)

kernel_name = 'interleave_layers__ssm_conv_h3__ssm_conv_s4d__prompt'

def setup_inputs():

    _w = (lambda a: (lambda t: t.to(torch.bfloat16) if t.is_floating_point() else t)(torch.as_tensor(a)))
    def _A_setup():
        B, S, D = 1, 2048, 512
        ks = 4
        return {
            "q": _w((lambda *s: torch.randn(*s, dtype=torch.bfloat16) * 0.05)(B, S, D)),
            "k": _w((lambda *s: torch.randn(*s, dtype=torch.bfloat16) * 0.4)(B, S, D)),
            "v": _w((lambda *s: torch.randn(*s, dtype=torch.bfloat16) * 0.4)(B, S, D)),
            "shift_k": _w((lambda *s: torch.randn(*s, dtype=torch.bfloat16) * 0.4)(D, ks) * 0.5),
            "ssm_k": _w((lambda *s: torch.randn(*s, dtype=torch.bfloat16) * 0.4)(D, S) * (1.0 / S ** 0.5)),
            "ssm_D": _w((lambda *s: torch.randn(*s, dtype=torch.bfloat16) * 0.4)(D)),
        }
    _A_in = _A_setup()

    def _B_setup():
        Bsz, L, D, N = 1, 2048, 512, 128
        return {
            "u": _w((lambda *s: torch.randn(*s, dtype=torch.bfloat16) * 0.05)(Bsz, L, D)),
            "log_A_real": _w((lambda *s: torch.randn(*s, dtype=torch.bfloat16) * 6.4)(D, N) * 0.5),
            "A_imag": _w((lambda *s: torch.randn(*s, dtype=torch.bfloat16) * 0.05)(D, N) * 3.14),
            "C_real": _w((lambda *s: torch.randn(*s, dtype=torch.bfloat16) * 0.1)(D, N) / N ** 0.5),
            "C_imag": _w((lambda *s: torch.randn(*s, dtype=torch.bfloat16) * 0.1)(D, N) / N ** 0.5),
            "log_dt": _w((lambda *s: torch.randn(*s, dtype=torch.bfloat16) * 0.05)(D) * 0.5 - 4.0),
            "D_skip": _w((lambda *s: torch.randn(*s, dtype=torch.bfloat16) * 0.05)(D)),
        }
    _B_in = _B_setup()

    return {
        "A_q": _A_in["q"],
        "A_k": _A_in["k"],
        "A_v": _A_in["v"],
        "A_shift_k": _A_in["shift_k"],
        "A_ssm_k": _A_in["ssm_k"],
        "A_ssm_D": _A_in["ssm_D"],
        "B_u": _B_in["u"],
        "B_log_A_real": _B_in["log_A_real"],
        "B_A_imag": _B_in["A_imag"],
        "B_C_real": _B_in["C_real"],
        "B_C_imag": _B_in["C_imag"],
        "B_log_dt": _B_in["log_dt"],
        "B_D_skip": _B_in["D_skip"],
    }

def reference(A_q, A_k, A_v, A_shift_k, A_ssm_k, A_ssm_D, B_u, B_log_A_real, B_A_imag, B_C_real, B_C_imag, B_log_dt, B_D_skip):
    def _A_ref(q, k, v, shift_k, ssm_k, ssm_D):
        B, S, D = q.shape
        ks = shift_k.shape[-1]
        k_pad = _pad(k, ((0, 0), (ks - 1, 0), (0, 0)))
        k_shift = torch.zeros_like(k)
        for t in range(ks):
            k_shift = k_shift + k_pad[:, t:t + S, :] * shift_k[:, ks - 1 - t][None, None, :]
        kv = k_shift * v
        L = 2 * S
        kv_pad = _pad(kv, ((0, 0), (0, S), (0, 0)))
        kf_pad = _pad(ssm_k, ((0, 0), (0, S)))
        kv_f = (lambda x, axes=(-2,-1): torch.fft.rfft2(x.float(), dim=axes))(kv_pad[:, None, :, :], axes=(1, 2))
        kf_f = (lambda x, axes=(-2,-1): torch.fft.rfft2(x.float(), dim=axes))(kf_pad[:, None, :], axes=(1, 2))
        kf_f = (lambda x, *d: x.permute(*d))(kf_f, 1, 2, 0)
        y_f = kv_f * kf_f[None, :, :, :]
        y = (lambda x, s, axes=(-2,-1): torch.fft.irfft2(x, s=s, dim=axes).to(torch.bfloat16))(y_f, (1, L), axes=(1, 2))[:, 0, :S, :]
        y = y + kv * ssm_D[None, None, :]
        return q * y

    def _B_ref(u, log_A_real, A_imag, C_real, C_imag, log_dt, D_skip):
        L = u.shape[1]
        dt = torch.exp(log_dt)
        A = -torch.exp(log_A_real) + 1j * A_imag
        C = (C_real + 1j * C_imag) * dt[:, None]
        pos = (lambda x, dt: x.to(dt))(torch.arange(L), log_dt.dtype)
        P = torch.exp((A * dt[:, None])[:, :, None] * pos[None, None, :])
        K = 2.0 * torch.einsum("dn,dnl->dl", C, P).real
        L2 = 2 * L
        u_t = (lambda x, *d: x.permute(*d))(u, 0, 2, 1)
        Kf = (lambda x, *a, **k: torch.fft.rfft(x.float(), *a, **k))(K, L2)
        Uf = (lambda x, *a, **k: torch.fft.rfft(x.float(), *a, **k))(u_t, L2)
        y = (lambda x, *a, **k: torch.fft.irfft(x, *a, **k).to(torch.bfloat16))(Uf * Kf[None, :, :], L2)[:, :, :L]
        y = (lambda x, *d: x.permute(*d))(y, 0, 2, 1)
        return y + u * D_skip[None, None, :]

    x = A_q
    x = x + _A_ref(_layernorm(x, axis=-1), A_k, A_v, A_shift_k, A_ssm_k, A_ssm_D)
    x = x + _B_ref(_layernorm(x, axis=-1), B_log_A_real, B_A_imag, B_C_real, B_C_imag, B_log_dt, B_D_skip)
    x = x + _A_ref(_layernorm(x, axis=-1), A_k, A_v, A_shift_k, A_ssm_k, A_ssm_D)
    x = x + _B_ref(_layernorm(x, axis=-1), B_log_A_real, B_A_imag, B_C_real, B_C_imag, B_log_dt, B_D_skip)
    return x
```

```asm
; @launch kernel=p_kernel grid=(256,1,1) block=(512,1,1) lds=73024
.amdgcn_target "amdgcn-amd-amdhsa--gfx950"
.text
.globl p_kernel
.p2align 8
.type p_kernel,@function
p_kernel:
    s_getpc_b64 s[98:99]
    s_cmp_ge_u32 s2, 256
    s_cbranch_scc1 F1_done
    s_and_b32 s17, s2, 7
    s_lshl_b32 s17, s17, 5
    s_lshr_b32 s3, s2, 3
    s_add_u32 s3, s3, s17
    v_readfirstlane_b32 s16, v0
    v_and_b32 v0, 255, v0
    s_cmp_ge_u32 s16, 256
    s_cbranch_scc1 F1_H
    s_lshr_b32 s4, s2, 3
    s_mul_i32 s4, s4, 10
    v_add_u32 v1, s4, v0
    v_lshlrev_b32 v1, 7, v1
    v_cmp_gt_u32 vcc, 10, v0
    s_mov_b32 s4, CODE_END-p_kernel-8
    v_cmp_gt_u32 s[6:7], s4, v1
    s_and_b64 vcc, vcc, s[6:7]
    s_and_saveexec_b64 s[6:7], vcc
    s_cbranch_execz F1_nopf
    global_load_dword v95, v1, s[98:99]
F1_nopf:
    s_mov_b64 exec, s[6:7]
    s_load_dwordx8 s[4:11], s[0:1], 56
    s_load_dwordx2 s[12:13], s[0:1], 88
    s_load_dwordx2 s[14:15], s[0:1], 120
    s_lshl_b32 s16, s3, 9
    v_lshlrev_b32 v1, 1, v0
    v_add_u32 v1, s16, v1
    v_lshrrev_b32 v2, 7, v0
    s_lshl_b32 s16, s3, 2
    v_lshlrev_b32 v3, 1, v2
    v_add_u32 v3, s16, v3
    s_waitcnt lgkmcnt(0)
    s_mov_b32 s20, s4
    s_mov_b32 s21, s5
    s_mov_b32 s22, 0x20000
    s_mov_b32 s23, 0x20000
    s_mov_b32 s24, s6
    s_mov_b32 s25, s7
    s_mov_b32 s26, 0x20000
    s_mov_b32 s27, 0x20000
    s_mov_b32 s28, s8
    s_mov_b32 s29, s9
    s_mov_b32 s30, 0x20000
    s_mov_b32 s31, 0x20000
    s_mov_b32 s32, s10
    s_mov_b32 s33, s11
    s_mov_b32 s34, 0x20000
    s_mov_b32 s35, 0x20000
    s_mov_b32 s36, s12
    s_mov_b32 s37, s13
    s_mov_b32 s38, 0x400
    s_mov_b32 s39, 0x20000
    buffer_load_ushort v4, v3, s[36:39], 0 offen
    buffer_load_ushort v5, v1, s[20:23], 0 offen
    buffer_load_ushort v6, v1, s[24:27], 0 offen
    buffer_load_ushort v7, v1, s[28:31], 0 offen
    buffer_load_ushort v8, v1, s[32:35], 0 offen
    v_mov_b32 v9, 0
    v_and_b32 v10, 15, v0
    v_lshlrev_b32 v10, 2, v10
    ds_write_b32 v10, v9 offset:42496
    s_waitcnt lgkmcnt(0)
    s_barrier
    s_add_u32 s40, s14, 0x1000000
    s_addc_u32 s41, s15, 0
    s_mov_b32 s42, 0x180000
    s_mov_b32 s43, 0x20000
    s_add_u32 s56, s14, 0x1400000
    s_addc_u32 s57, s15, 0
    s_mov_b32 s58, 0x10800
    s_mov_b32 s59, 0x20000
    v_mov_b32 v9, -1
    s_lshl_b32 s16, s3, 8
    v_lshlrev_b32 v10, 2, v0
    v_add_u32 v10, s16, v10
    v_cmp_gt_u32 vcc, 64, v0
    s_and_saveexec_b64 s[18:19], vcc
    s_cbranch_execz KG_noinit
    buffer_store_dword v9, v10, s[56:59], 0 offen sc1
KG_noinit:
    s_mov_b64 exec, s[18:19]
    v_and_b32 v10, 15, v0
    v_bfe_u32 v11, v0, 4, 2
    v_lshrrev_b32 v12, 3, v10
    v_lshlrev_b32 v12, 7, v12
    v_and_b32 v13, 7, v10
    v_add_u32 v12, v12, v13
    v_lshrrev_b32 v13, 2, v10
    v_lshlrev_b32 v13, 7, v13
    v_and_b32 v14, 3, v10
    v_lshl_add_u32 v13, v14, 1, v13
    v_add_u32 v13, 0x100, v13
    v_and_b32 v14, 7, v10
    v_lshrrev_b32 v14, 1, v14
    v_lshlrev_b32 v14, 7, v14
    v_and_b32 v15, 1, v10
    v_lshl_add_u32 v14, v15, 2, v14
    v_add_u32 v14, 0x200, v14
    v_cmp_gt_u32 vcc, 8, v10
    s_nop 1
    v_cndmask_b32 v13, v14, v13, vcc
    v_lshlrev_b32 v14, 7, v10
    v_add_u32 v14, 0x400, v14
    v_cmp_gt_u32 s[60:61], 9, v10
    s_nop 1
    v_cndmask_b32 v14, 0, v14, s[60:61]
    v_lshlrev_b32 v15, 3, v10
    v_cvt_f32_u32 v16, v12
    v_cvt_f32_u32 v17, v12
    v_cvt_f32_u32 v18, v13
    v_cvt_f32_u32 v19, v13
    v_cvt_f32_u32 v20, v14
    v_cvt_f32_u32 v21, v14
    v_cvt_f32_u32 v22, v15
    v_cvt_f32_u32 v23, v15
    v_mul_u32_u24 v24, 9856, v2
    v_mul_u32_u24 v9, 144, v11
    v_add3_u32 v24, v24, v9, 0
    v_add_u32 v24, 47104, v24
    v_lshrrev_b32 v9, 3, v12
    v_add_u32 v9, v9, v12
    v_lshl_add_u32 v25, v9, 2, v24
    v_lshrrev_b32 v9, 3, v13
    v_add_u32 v9, v9, v13
    v_lshl_add_u32 v26, v9, 2, v24
    v_lshrrev_b32 v9, 3, v14
    v_add_u32 v9, v9, v14
    v_lshl_add_u32 v27, v9, 2, v24
    v_and_b32 v9, 63, v0
    v_lshlrev_b32 v9, 4, v9
    v_mul_u32_u24 v24, 3072, v2
    v_add_u32 v9, v9, v24
    v_add_u32 v9, 66816, v9
    v_lshlrev_b32 v28, 4, v0
    v_add_u32 v28, 43008, v28
    v_lshrrev_b32 v29, 6, v0
    v_lshlrev_b32 v29, 10, v29
    v_lshl_add_u32 v29, v11, 6, v29
    v_add_u32 v29, 43008, v29
    s_mov_b32 s50, 0x3fb8aa3b
    s_mov_b32 s51, 0x32a57060
    s_mov_b32 s52, 0x3f317218
    s_mov_b32 s53, 0x3e22f983
    s_waitcnt vmcnt(0)
    v_lshlrev_b32 v4, 16, v4
    v_lshlrev_b32 v5, 16, v5
    v_lshlrev_b32 v6, 16, v6
    v_lshlrev_b32 v7, 16, v7
    v_lshlrev_b32 v8, 16, v8
    v_mul_f32 v30, s50, v4
    v_mul_f32 v32, s50, v5
    v_fma_f32 v31, v4, s50, -v30
    v_fma_f32 v33, v5, s50, -v32
    v_fma_f32 v31, v4, s51, v31
    v_fma_f32 v33, v5, s51, v33
    v_exp_f32 v30, v30
    v_exp_f32 v32, v32
    v_mul_f32 v31, s52, v31
    v_mul_f32 v33, s52, v33
    v_fma_f32 v4, v30, v31, v30
    v_fma_f32 v5, v32, v33, v32
    v_cvt_pk_bf16_f32 v4, v4, v4
    v_cvt_pk_bf16_f32 v5, v5, v5
    v_lshlrev_b32 v4, 16, v4
    v_lshlrev_b32 v5, 16, v5
    v_mul_f32 v36, v5, v4
    v_mul_f32 v37, v6, v4
    v_mul_f32 v38, v7, v4
    v_mul_f32 v39, v8, v4
    v_mul_f32 v36, s50, v36
    v_mul_f32 v37, s53, v37
    v_add_f32 v38, v38, v38
    v_add_f32 v39, v39, v39
    v_sub_f32 v36, 0, v36
    v_add_f32 v30, abs(v38), abs(v39)
    s_nop 1
    v_add_f32_dpp v30, v30, v30 row_shr:1 row_mask:0xf bank_mask:0xf bound_ctrl:0
    s_nop 1
    v_add_f32_dpp v30, v30, v30 row_shr:2 row_mask:0xf bank_mask:0xf bound_ctrl:0
    s_nop 1
    v_add_f32_dpp v30, v30, v30 row_shr:4 row_mask:0xf bank_mask:0xf bound_ctrl:0
    s_nop 1
    v_add_f32_dpp v30, v30, v30 row_shr:8 row_mask:0xf bank_mask:0xf bound_ctrl:0
    s_nop 1
    v_add_f32_dpp v30, v30, v30 row_bcast:15 row_mask:0xa bank_mask:0xf
    s_nop 1
    v_add_f32_dpp v30, v30, v30 row_bcast:31 row_mask:0xc bank_mask:0xf
    v_lshrrev_b32 v31, 6, v0
    v_lshlrev_b32 v31, 2, v31
    v_add_u32 v31, 72960, v31
    v_and_b32 v32, 63, v0
    v_cmp_eq_u32 vcc, 63, v32
    s_and_saveexec_b64 s[18:19], vcc
    ds_write_b32 v31, v30
    s_mov_b64 exec, s[18:19]
    ds_write_b128 v28, v[36:39]
    v_accvgpr_write_b32 a0, 0
    v_accvgpr_write_b32 a1, 0
    v_accvgpr_write_b32 a2, 0
    v_accvgpr_write_b32 a3, 0
    v_accvgpr_write_b32 a4, 0
    v_accvgpr_write_b32 a5, 0
    v_accvgpr_write_b32 a6, 0
    v_accvgpr_write_b32 a7, 0
    v_accvgpr_write_b32 a8, 0
    v_accvgpr_write_b32 a9, 0
    v_accvgpr_write_b32 a10, 0
    v_accvgpr_write_b32 a11, 0
    s_waitcnt lgkmcnt(0)
    ds_read_b128 v[30:33], v29 offset:0
    ds_read_b128 v[34:37], v29 offset:16
    ds_read_b128 v[38:41], v29 offset:32
    ds_read_b128 v[42:45], v29 offset:48
    s_waitcnt lgkmcnt(0)
    v_pk_mul_f32 v[78:79], v[30:31], v[16:17]
    v_pk_mul_f32 v[86:87], v[34:35], v[16:17]
    v_fract_f32 v79, v79
    v_fract_f32 v87, v87
    v_exp_f32 v82, v78
    v_exp_f32 v90, v86
    v_cos_f32 v80, v79
    v_cos_f32 v88, v87
    v_sin_f32 v81, v79
    v_sin_f32 v89, v87
    v_pk_mul_f32 v[78:79], v[80:81], v[82:83] op_sel_hi:[1,0]
    v_pk_mul_f32 v[86:87], v[88:89], v[90:91] op_sel_hi:[1,0]
    v_cvt_pk_bf16_f32 v54, v78, v79
    v_cvt_pk_bf16_f32 v55, v86, v87
    v_lshlrev_b32 v84, 16, v54
    v_lshlrev_b32 v92, 16, v55
    v_and_b32 v85, 0xffff0000, v54
    v_and_b32 v93, 0xffff0000, v55
    v_pk_add_f32 v[78:79], v[78:79], v[84:85] neg_lo:[0,1] neg_hi:[0,1]
    v_pk_add_f32 v[86:87], v[86:87], v[92:93] neg_lo:[0,1] neg_hi:[0,1]
    v_cvt_pk_bf16_f32 v66, v78, v79
    v_cvt_pk_bf16_f32 v67, v86, v87
    v_pk_mul_f32 v[78:79], v[38:39], v[16:17]
    v_pk_mul_f32 v[86:87], v[42:43], v[16:17]
    v_fract_f32 v79, v79
    v_fract_f32 v87, v87
    v_exp_f32 v82, v78
    v_exp_f32 v90, v86
    v_cos_f32 v80, v79
    v_cos_f32 v88, v87
    v_sin_f32 v81, v79
    v_sin_f32 v89, v87
    v_pk_mul_f32 v[78:79], v[80:81], v[82:83] op_sel_hi:[1,0]
    v_pk_mul_f32 v[86:87], v[88:89], v[90:91] op_sel_hi:[1,0]
    v_cvt_pk_bf16_f32 v56, v78, v79
    v_cvt_pk_bf16_f32 v57, v86, v87
    v_lshlrev_b32 v84, 16, v56
    v_lshlrev_b32 v92, 16, v57
    v_and_b32 v85, 0xffff0000, v56
    v_and_b32 v93, 0xffff0000, v57
    v_pk_add_f32 v[78:79], v[78:79], v[84:85] neg_lo:[0,1] neg_hi:[0,1]
    v_pk_add_f32 v[86:87], v[86:87], v[92:93] neg_lo:[0,1] neg_hi:[0,1]
    v_cvt_pk_bf16_f32 v68, v78, v79
    v_cvt_pk_bf16_f32 v69, v86, v87
    v_pk_mul_f32 v[78:79], v[30:31], v[18:19]
    v_pk_mul_f32 v[86:87], v[34:35], v[18:19]
    v_fract_f32 v79, v79
    v_fract_f32 v87, v87
    v_exp_f32 v82, v78
    v_exp_f32 v90, v86
    v_cos_f32 v80, v79
    v_cos_f32 v88, v87
    v_sin_f32 v81, v79
    v_sin_f32 v89, v87
    v_pk_mul_f32 v[78:79], v[80:81], v[82:83] op_sel_hi:[1,0]
    v_pk_mul_f32 v[86:87], v[88:89], v[90:91] op_sel_hi:[1,0]
    v_cvt_pk_bf16_f32 v58, v78, v79
    v_cvt_pk_bf16_f32 v59, v86, v87
    v_lshlrev_b32 v84, 16, v58
    v_lshlrev_b32 v92, 16, v59
    v_and_b32 v85, 0xffff0000, v58
    v_and_b32 v93, 0xffff0000, v59
    v_pk_add_f32 v[78:79], v[78:79], v[84:85] neg_lo:[0,1] neg_hi:[0,1]
    v_pk_add_f32 v[86:87], v[86:87], v[92:93] neg_lo:[0,1] neg_hi:[0,1]
    v_cvt_pk_bf16_f32 v70, v78, v79
    v_cvt_pk_bf16_f32 v71, v86, v87
    v_pk_mul_f32 v[78:79], v[38:39], v[18:19]
    v_pk_mul_f32 v[86:87], v[42:43], v[18:19]
    v_fract_f32 v79, v79
    v_fract_f32 v87, v87
    v_exp_f32 v82, v78
    v_exp_f32 v90, v86
    v_cos_f32 v80, v79
    v_cos_f32 v88, v87
    v_sin_f32 v81, v79
    v_sin_f32 v89, v87
    v_pk_mul_f32 v[78:79], v[80:81], v[82:83] op_sel_hi:[1,0]
    v_pk_mul_f32 v[86:87], v[88:89], v[90:91] op_sel_hi:[1,0]
    v_cvt_pk_bf16_f32 v60, v78, v79
    v_cvt_pk_bf16_f32 v61, v86, v87
    v_lshlrev_b32 v84, 16, v60
    v_lshlrev_b32 v92, 16, v61
    v_and_b32 v85, 0xffff0000, v60
    v_and_b32 v93, 0xffff0000, v61
    v_pk_add_f32 v[78:79], v[78:79], v[84:85] neg_lo:[0,1] neg_hi:[0,1]
    v_pk_add_f32 v[86:87], v[86:87], v[92:93] neg_lo:[0,1] neg_hi:[0,1]
    v_cvt_pk_bf16_f32 v72, v78, v79
    v_cvt_pk_bf16_f32 v73, v86, v87
    v_pk_mul_f32 v[78:79], v[30:31], v[20:21]
    v_pk_mul_f32 v[86:87], v[34:35], v[20:21]
    v_fract_f32 v79, v79
    v_fract_f32 v87, v87
    v_exp_f32 v82, v78
    v_exp_f32 v90, v86
    v_cos_f32 v80, v79
    v_cos_f32 v88, v87
    v_sin_f32 v81, v79
    v_sin_f32 v89, v87
    v_pk_mul_f32 v[78:79], v[80:81], v[82:83] op_sel_hi:[1,0]
    v_pk_mul_f32 v[86:87], v[88:89], v[90:91] op_sel_hi:[1,0]
    v_cvt_pk_bf16_f32 v62, v78, v79
    v_cvt_pk_bf16_f32 v63, v86, v87
    v_lshlrev_b32 v84, 16, v62
    v_lshlrev_b32 v92, 16, v63
    v_and_b32 v85, 0xffff0000, v62
    v_and_b32 v93, 0xffff0000, v63
    v_pk_add_f32 v[78:79], v[78:79], v[84:85] neg_lo:[0,1] neg_hi:[0,1]
    v_pk_add_f32 v[86:87], v[86:87], v[92:93] neg_lo:[0,1] neg_hi:[0,1]
    v_cvt_pk_bf16_f32 v74, v78, v79
    v_cvt_pk_bf16_f32 v75, v86, v87
    v_pk_mul_f32 v[78:79], v[38:39], v[20:21]
    v_pk_mul_f32 v[86:87], v[42:43], v[20:21]
    v_fract_f32 v79, v79
    v_fract_f32 v87, v87
    v_exp_f32 v82, v78
    v_exp_f32 v90, v86
    v_cos_f32 v80, v79
    v_cos_f32 v88, v87
    v_sin_f32 v81, v79
    v_sin_f32 v89, v87
    v_pk_mul_f32 v[78:79], v[80:81], v[82:83] op_sel_hi:[1,0]
    v_pk_mul_f32 v[86:87], v[88:89], v[90:91] op_sel_hi:[1,0]
    v_cvt_pk_bf16_f32 v64, v78, v79
    v_cvt_pk_bf16_f32 v65, v86, v87
    v_lshlrev_b32 v84, 16, v64
    v_lshlrev_b32 v92, 16, v65
    v_and_b32 v85, 0xffff0000, v64
    v_and_b32 v93, 0xffff0000, v65
    v_pk_add_f32 v[78:79], v[78:79], v[84:85] neg_lo:[0,1] neg_hi:[0,1]
    v_pk_add_f32 v[86:87], v[86:87], v[92:93] neg_lo:[0,1] neg_hi:[0,1]
    v_cvt_pk_bf16_f32 v76, v78, v79
    v_cvt_pk_bf16_f32 v77, v86, v87
    v_pk_mul_f32 v[78:79], v[30:31], v[22:23]
    v_pk_mul_f32 v[86:87], v[34:35], v[22:23]
    v_fract_f32 v79, v79
    v_fract_f32 v87, v87
    v_exp_f32 v82, v78
    v_exp_f32 v90, v86
    v_cos_f32 v80, v79
    v_cos_f32 v88, v87
    v_sin_f32 v81, v79
    v_sin_f32 v89, v87
    v_pk_mul_f32 v[78:79], v[80:81], v[82:83] op_sel_hi:[1,0]
    v_pk_mul_f32 v[86:87], v[88:89], v[90:91] op_sel_hi:[1,0]
    v_pk_mul_f32 v[84:85], v[78:79], v[32:33] op_sel_hi:[0,1]
    v_pk_mul_f32 v[92:93], v[86:87], v[36:37] op_sel_hi:[0,1]
    v_fma_f32 v78, -v79, v33, v84
    v_fma_f32 v86, -v87, v37, v92
    v_fma_f32 v79, -v79, v32, -v85
    v_fma_f32 v87, -v87, v36, -v93
    v_cvt_pk_bf16_f32 v46, v78, v79
    v_cvt_pk_bf16_f32 v47, v86, v87
    v_lshlrev_b32 v84, 16, v46
    v_lshlrev_b32 v92, 16, v47
    v_and_b32 v85, 0xffff0000, v46
    v_and_b32 v93, 0xffff0000, v47
    v_pk_add_f32 v[78:79], v[78:79], v[84:85] neg_lo:[0,1] neg_hi:[0,1]
    v_pk_add_f32 v[86:87], v[86:87], v[92:93] neg_lo:[0,1] neg_hi:[0,1]
    v_cvt_pk_bf16_f32 v50, v78, v79
    v_cvt_pk_bf16_f32 v51, v86, v87
    v_pk_mul_f32 v[78:79], v[38:39], v[22:23]
    v_pk_mul_f32 v[86:87], v[42:43], v[22:23]
    v_fract_f32 v79, v79
    v_fract_f32 v87, v87
    v_exp_f32 v82, v78
    v_exp_f32 v90, v86
    v_cos_f32 v80, v79
    v_cos_f32 v88, v87
    v_sin_f32 v81, v79
    v_sin_f32 v89, v87
    v_pk_mul_f32 v[78:79], v[80:81], v[82:83] op_sel_hi:[1,0]
    v_pk_mul_f32 v[86:87], v[88:89], v[90:91] op_sel_hi:[1,0]
    v_pk_mul_f32 v[84:85], v[78:79], v[40:41] op_sel_hi:[0,1]
    v_pk_mul_f32 v[92:93], v[86:87], v[44:45] op_sel_hi:[0,1]
    v_fma_f32 v78, -v79, v41, v84
    v_fma_f32 v86, -v87, v45, v92
    v_fma_f32 v79, -v79, v40, -v85
    v_fma_f32 v87, -v87, v44, -v93
    v_cvt_pk_bf16_f32 v48, v78, v79
    v_cvt_pk_bf16_f32 v49, v86, v87
    v_lshlrev_b32 v84, 16, v48
    v_lshlrev_b32 v92, 16, v49
    v_and_b32 v85, 0xffff0000, v48
    v_and_b32 v93, 0xffff0000, v49
    v_pk_add_f32 v[78:79], v[78:79], v[84:85] neg_lo:[0,1] neg_hi:[0,1]
    v_pk_add_f32 v[86:87], v[86:87], v[92:93] neg_lo:[0,1] neg_hi:[0,1]
    v_cvt_pk_bf16_f32 v52, v78, v79
    v_cvt_pk_bf16_f32 v53, v86, v87
    v_mfma_f32_16x16x32_bf16 a[0:3], v[46:49], v[54:57], a[0:3]
    v_mfma_f32_16x16x32_bf16 a[4:7], v[46:49], v[58:61], a[4:7]
    v_mfma_f32_16x16x32_bf16 a[8:11], v[46:49], v[62:65], a[8:11]
    v_mfma_f32_16x16x32_bf16 a[0:3], v[46:49], v[66:69], a[0:3]
    v_mfma_f32_16x16x32_bf16 a[4:7], v[46:49], v[70:73], a[4:7]
    v_mfma_f32_16x16x32_bf16 a[8:11], v[46:49], v[74:77], a[8:11]
    v_mfma_f32_16x16x32_bf16 a[0:3], v[50:53], v[54:57], a[0:3]
    v_mfma_f32_16x16x32_bf16 a[4:7], v[50:53], v[58:61], a[4:7]
    v_mfma_f32_16x16x32_bf16 a[8:11], v[50:53], v[62:65], a[8:11]
    ds_read_b128 v[30:33], v29 offset:256
    ds_read_b128 v[34:37], v29 offset:272
    ds_read_b128 v[38:41], v29 offset:288
    ds_read_b128 v[42:45], v29 offset:304
    s_waitcnt lgkmcnt(0)
    v_pk_mul_f32 v[78:79], v[30:31], v[16:17]
    v_pk_mul_f32 v[86:87], v[34:35], v[16:17]
    v_fract_f32 v79, v79
    v_fract_f32 v87, v87
    v_exp_f32 v82, v78
    v_exp_f32 v90, v86
    v_cos_f32 v80, v79
    v_cos_f32 v88, v87
    v_sin_f32 v81, v79
    v_sin_f32 v89, v87
    v_pk_mul_f32 v[78:79], v[80:81], v[82:83] op_sel_hi:[1,0]
    v_pk_mul_f32 v[86:87], v[88:89], v[90:91] op_sel_hi:[1,0]
    v_cvt_pk_bf16_f32 v54, v78, v79
    v_cvt_pk_bf16_f32 v55, v86, v87
    v_lshlrev_b32 v84, 16, v54
    v_lshlrev_b32 v92, 16, v55
    v_and_b32 v85, 0xffff0000, v54
    v_and_b32 v93, 0xffff0000, v55
    v_pk_add_f32 v[78:79], v[78:79], v[84:85] neg_lo:[0,1] neg_hi:[0,1]
    v_pk_add_f32 v[86:87], v[86:87], v[92:93] neg_lo:[0,1] neg_hi:[0,1]
    v_cvt_pk_bf16_f32 v66, v78, v79
    v_cvt_pk_bf16_f32 v67, v86, v87
    v_pk_mul_f32 v[78:79], v[38:39], v[16:17]
    v_pk_mul_f32 v[86:87], v[42:43], v[16:17]
    v_fract_f32 v79, v79
    v_fract_f32 v87, v87
    v_exp_f32 v82, v78
    v_exp_f32 v90, v86
    v_cos_f32 v80, v79
    v_cos_f32 v88, v87
    v_sin_f32 v81, v79
    v_sin_f32 v89, v87
    v_pk_mul_f32 v[78:79], v[80:81], v[82:83] op_sel_hi:[1,0]
    v_pk_mul_f32 v[86:87], v[88:89], v[90:91] op_sel_hi:[1,0]
    v_cvt_pk_bf16_f32 v56, v78, v79
    v_cvt_pk_bf16_f32 v57, v86, v87
    v_lshlrev_b32 v84, 16, v56
    v_lshlrev_b32 v92, 16, v57
    v_and_b32 v85, 0xffff0000, v56
    v_and_b32 v93, 0xffff0000, v57
    v_pk_add_f32 v[78:79], v[78:79], v[84:85] neg_lo:[0,1] neg_hi:[0,1]
    v_pk_add_f32 v[86:87], v[86:87], v[92:93] neg_lo:[0,1] neg_hi:[0,1]
    v_cvt_pk_bf16_f32 v68, v78, v79
    v_cvt_pk_bf16_f32 v69, v86, v87
    v_pk_mul_f32 v[78:79], v[30:31], v[18:19]
    v_pk_mul_f32 v[86:87], v[34:35], v[18:19]
    v_fract_f32 v79, v79
    v_fract_f32 v87, v87
    v_exp_f32 v82, v78
    v_exp_f32 v90, v86
    v_cos_f32 v80, v79
    v_cos_f32 v88, v87
    v_sin_f32 v81, v79
    v_sin_f32 v89, v87
    v_pk_mul_f32 v[78:79], v[80:81], v[82:83] op_sel_hi:[1,0]
    v_pk_mul_f32 v[86:87], v[88:89], v[90:91] op_sel_hi:[1,0]
    v_cvt_pk_bf16_f32 v58, v78, v79
    v_cvt_pk_bf16_f32 v59, v86, v87
    v_lshlrev_b32 v84, 16, v58
    v_lshlrev_b32 v92, 16, v59
    v_and_b32 v85, 0xffff0000, v58
    v_and_b32 v93, 0xffff0000, v59
    v_pk_add_f32 v[78:79], v[78:79], v[84:85] neg_lo:[0,1] neg_hi:[0,1]
    v_pk_add_f32 v[86:87], v[86:87], v[92:93] neg_lo:[0,1] neg_hi:[0,1]
    v_cvt_pk_bf16_f32 v70, v78, v79
    v_cvt_pk_bf16_f32 v71, v86, v87
    v_pk_mul_f32 v[78:79], v[38:39], v[18:19]
    v_pk_mul_f32 v[86:87], v[42:43], v[18:19]
    v_fract_f32 v79, v79
    v_fract_f32 v87, v87
    v_exp_f32 v82, v78
    v_exp_f32 v90, v86
    v_cos_f32 v80, v79
    v_cos_f32 v88, v87
    v_sin_f32 v81, v79
    v_sin_f32 v89, v87
    v_pk_mul_f32 v[78:79], v[80:81], v[82:83] op_sel_hi:[1,0]
    v_pk_mul_f32 v[86:87], v[88:89], v[90:91] op_sel_hi:[1,0]
    v_cvt_pk_bf16_f32 v60, v78, v79
    v_cvt_pk_bf16_f32 v61, v86, v87
    v_lshlrev_b32 v84, 16, v60
    v_lshlrev_b32 v92, 16, v61
    v_and_b32 v85, 0xffff0000, v60
    v_and_b32 v93, 0xffff0000, v61
    v_pk_add_f32 v[78:79], v[78:79], v[84:85] neg_lo:[0,1] neg_hi:[0,1]
    v_pk_add_f32 v[86:87], v[86:87], v[92:93] neg_lo:[0,1] neg_hi:[0,1]
    v_cvt_pk_bf16_f32 v72, v78, v79
    v_cvt_pk_bf16_f32 v73, v86, v87
    v_pk_mul_f32 v[78:79], v[30:31], v[20:21]
    v_pk_mul_f32 v[86:87], v[34:35], v[20:21]
    v_fract_f32 v79, v79
    v_fract_f32 v87, v87
    v_exp_f32 v82, v78
    v_exp_f32 v90, v86
    v_cos_f32 v80, v79
    v_cos_f32 v88, v87
    v_sin_f32 v81, v79
    v_sin_f32 v89, v87
    v_pk_mul_f32 v[78:79], v[80:81], v[82:83] op_sel_hi:[1,0]
    v_pk_mul_f32 v[86:87], v[88:89], v[90:91] op_sel_hi:[1,0]
    v_cvt_pk_bf16_f32 v62, v78, v79
    v_cvt_pk_bf16_f32 v63, v86, v87
    v_lshlrev_b32 v84, 16, v62
    v_lshlrev_b32 v92, 16, v63
    v_and_b32 v85, 0xffff0000, v62
    v_and_b32 v93, 0xffff0000, v63
    v_pk_add_f32 v[78:79], v[78:79], v[84:85] neg_lo:[0,1] neg_hi:[0,1]
    v_pk_add_f32 v[86:87], v[86:87], v[92:93] neg_lo:[0,1] neg_hi:[0,1]
    v_cvt_pk_bf16_f32 v74, v78, v79
    v_cvt_pk_bf16_f32 v75, v86, v87
    v_pk_mul_f32 v[78:79], v[38:39], v[20:21]
    v_pk_mul_f32 v[86:87], v[42:43], v[20:21]
    v_fract_f32 v79, v79
    v_fract_f32 v87, v87
    v_exp_f32 v82, v78
    v_exp_f32 v90, v86
    v_cos_f32 v80, v79
    v_cos_f32 v88, v87
    v_sin_f32 v81, v79
    v_sin_f32 v89, v87
    v_pk_mul_f32 v[78:79], v[80:81], v[82:83] op_sel_hi:[1,0]
    v_pk_mul_f32 v[86:87], v[88:89], v[90:91] op_sel_hi:[1,0]
    v_cvt_pk_bf16_f32 v64, v78, v79
    v_cvt_pk_bf16_f32 v65, v86, v87
    v_lshlrev_b32 v84, 16, v64
    v_lshlrev_b32 v92, 16, v65
    v_and_b32 v85, 0xffff0000, v64
    v_and_b32 v93, 0xffff0000, v65
    v_pk_add_f32 v[78:79], v[78:79], v[84:85] neg_lo:[0,1] neg_hi:[0,1]
    v_pk_add_f32 v[86:87], v[86:87], v[92:93] neg_lo:[0,1] neg_hi:[0,1]
    v_cvt_pk_bf16_f32 v76, v78, v79
    v_cvt_pk_bf16_f32 v77, v86, v87
    v_pk_mul_f32 v[78:79], v[30:31], v[22:23]
    v_pk_mul_f32 v[86:87], v[34:35], v[22:23]
    v_fract_f32 v79, v79
    v_fract_f32 v87, v87
    v_exp_f32 v82, v78
    v_exp_f32 v90, v86
    v_cos_f32 v80, v79
    v_cos_f32 v88, v87
    v_sin_f32 v81, v79
    v_sin_f32 v89, v87
    v_pk_mul_f32 v[78:79], v[80:81], v[82:83] op_sel_hi:[1,0]
    v_pk_mul_f32 v[86:87], v[88:89], v[90:91] op_sel_hi:[1,0]
    v_pk_mul_f32 v[84:85], v[78:79], v[32:33] op_sel_hi:[0,1]
    v_pk_mul_f32 v[92:93], v[86:87], v[36:37] op_sel_hi:[0,1]
    v_fma_f32 v78, -v79, v33, v84
    v_fma_f32 v86, -v87, v37, v92
    v_fma_f32 v79, -v79, v32, -v85
    v_fma_f32 v87, -v87, v36, -v93
    v_cvt_pk_bf16_f32 v46, v78, v79
    v_cvt_pk_bf16_f32 v47, v86, v87
    v_lshlrev_b32 v84, 16, v46
    v_lshlrev_b32 v92, 16, v47
    v_and_b32 v85, 0xffff0000, v46
    v_and_b32 v93, 0xffff0000, v47
    v_pk_add_f32 v[78:79], v[78:79], v[84:85] neg_lo:[0,1] neg_hi:[0,1]
    v_pk_add_f32 v[86:87], v[86:87], v[92:93] neg_lo:[0,1] neg_hi:[0,1]
    v_cvt_pk_bf16_f32 v50, v78, v79
    v_cvt_pk_bf16_f32 v51, v86, v87
    v_pk_mul_f32 v[78:79], v[38:39], v[22:23]
    v_pk_mul_f32 v[86:87], v[42:43], v[22:23]
    v_fract_f32 v79, v79
    v_fract_f32 v87, v87
    v_exp_f32 v82, v78
    v_exp_f32 v90, v86
    v_cos_f32 v80, v79
    v_cos_f32 v88, v87
    v_sin_f32 v81, v79
    v_sin_f32 v89, v87
    v_pk_mul_f32 v[78:79], v[80:81], v[82:83] op_sel_hi:[1,0]
    v_pk_mul_f32 v[86:87], v[88:89], v[90:91] op_sel_hi:[1,0]
    v_pk_mul_f32 v[84:85], v[78:79], v[40:41] op_sel_hi:[0,1]
    v_pk_mul_f32 v[92:93], v[86:87], v[44:45] op_sel_hi:[0,1]
    v_fma_f32 v78, -v79, v41, v84
    v_fma_f32 v86, -v87, v45, v92
    v_fma_f32 v79, -v79, v40, -v85
    v_fma_f32 v87, -v87, v44, -v93
    v_cvt_pk_bf16_f32 v48, v78, v79
    v_cvt_pk_bf16_f32 v49, v86, v87
    v_lshlrev_b32 v84, 16, v48
    v_lshlrev_b32 v92, 16, v49
    v_and_b32 v85, 0xffff0000, v48
    v_and_b32 v93, 0xffff0000, v49
    v_pk_add_f32 v[78:79], v[78:79], v[84:85] neg_lo:[0,1] neg_hi:[0,1]
    v_pk_add_f32 v[86:87], v[86:87], v[92:93] neg_lo:[0,1] neg_hi:[0,1]
    v_cvt_pk_bf16_f32 v52, v78, v79
    v_cvt_pk_bf16_f32 v53, v86, v87
    v_mfma_f32_16x16x32_bf16 a[0:3], v[46:49], v[54:57], a[0:3]
    v_mfma_f32_16x16x32_bf16 a[4:7], v[46:49], v[58:61], a[4:7]
    v_mfma_f32_16x16x32_bf16 a[8:11], v[46:49], v[62:65], a[8:11]
    v_mfma_f32_16x16x32_bf16 a[0:3], v[46:49], v[66:69], a[0:3]
    v_mfma_f32_16x16x32_bf16 a[4:7], v[46:49], v[70:73], a[4:7]
    v_mfma_f32_16x16x32_bf16 a[8:11], v[46:49], v[74:77], a[8:11]
    v_mfma_f32_16x16x32_bf16 a[0:3], v[50:53], v[54:57], a[0:3]
    v_mfma_f32_16x16x32_bf16 a[4:7], v[50:53], v[58:61], a[4:7]
    v_mfma_f32_16x16x32_bf16 a[8:11], v[50:53], v[62:65], a[8:11]
    ds_read_b128 v[30:33], v29 offset:512
    ds_read_b128 v[34:37], v29 offset:528
    ds_read_b128 v[38:41], v29 offset:544
    ds_read_b128 v[42:45], v29 offset:560
    s_waitcnt lgkmcnt(0)
    v_pk_mul_f32 v[78:79], v[30:31], v[16:17]
    v_pk_mul_f32 v[86:87], v[34:35], v[16:17]
    v_fract_f32 v79, v79
    v_fract_f32 v87, v87
    v_exp_f32 v82, v78
    v_exp_f32 v90, v86
    v_cos_f32 v80, v79
    v_cos_f32 v88, v87
    v_sin_f32 v81, v79
    v_sin_f32 v89, v87
    v_pk_mul_f32 v[78:79], v[80:81], v[82:83] op_sel_hi:[1,0]
    v_pk_mul_f32 v[86:87], v[88:89], v[90:91] op_sel_hi:[1,0]
    v_cvt_pk_bf16_f32 v54, v78, v79
    v_cvt_pk_bf16_f32 v55, v86, v87
    v_lshlrev_b32 v84, 16, v54
    v_lshlrev_b32 v92, 16, v55
    v_and_b32 v85, 0xffff0000, v54
    v_and_b32 v93, 0xffff0000, v55
    v_pk_add_f32 v[78:79], v[78:79], v[84:85] neg_lo:[0,1] neg_hi:[0,1]
    v_pk_add_f32 v[86:87], v[86:87], v[92:93] neg_lo:[0,1] neg_hi:[0,1]
    v_cvt_pk_bf16_f32 v66, v78, v79
    v_cvt_pk_bf16_f32 v67, v86, v87
    v_pk_mul_f32 v[78:79], v[38:39], v[16:17]
    v_pk_mul_f32 v[86:87], v[42:43], v[16:17]
    v_fract_f32 v79, v79
    v_fract_f32 v87, v87
    v_exp_f32 v82, v78
    v_exp_f32 v90, v86
    v_cos_f32 v80, v79
    v_cos_f32 v88, v87
    v_sin_f32 v81, v79
    v_sin_f32 v89, v87
    v_pk_mul_f32 v[78:79], v[80:81], v[82:83] op_sel_hi:[1,0]
    v_pk_mul_f32 v[86:87], v[88:89], v[90:91] op_sel_hi:[1,0]
    v_cvt_pk_bf16_f32 v56, v78, v79
    v_cvt_pk_bf16_f32 v57, v86, v87
    v_lshlrev_b32 v84, 16, v56
    v_lshlrev_b32 v92, 16, v57
    v_and_b32 v85, 0xffff0000, v56
    v_and_b32 v93, 0xffff0000, v57
    v_pk_add_f32 v[78:79], v[78:79], v[84:85] neg_lo:[0,1] neg_hi:[0,1]
    v_pk_add_f32 v[86:87], v[86:87], v[92:93] neg_lo:[0,1] neg_hi:[0,1]
    v_cvt_pk_bf16_f32 v68, v78, v79
    v_cvt_pk_bf16_f32 v69, v86, v87
    v_pk_mul_f32 v[78:79], v[30:31], v[18:19]
    v_pk_mul_f32 v[86:87], v[34:35], v[18:19]
    v_fract_f32 v79, v79
    v_fract_f32 v87, v87
    v_exp_f32 v82, v78
    v_exp_f32 v90, v86
    v_cos_f32 v80, v79
    v_cos_f32 v88, v87
    v_sin_f32 v81, v79
    v_sin_f32 v89, v87
    v_pk_mul_f32 v[78:79], v[80:81], v[82:83] op_sel_hi:[1,0]
    v_pk_mul_f32 v[86:87], v[88:89], v[90:91] op_sel_hi:[1,0]
    v_cvt_pk_bf16_f32 v58, v78, v79
    v_cvt_pk_bf16_f32 v59, v86, v87
    v_lshlrev_b32 v84, 16, v58
    v_lshlrev_b32 v92, 16, v59
    v_and_b32 v85, 0xffff0000, v58
    v_and_b32 v93, 0xffff0000, v59
    v_pk_add_f32 v[78:79], v[78:79], v[84:85] neg_lo:[0,1] neg_hi:[0,1]
    v_pk_add_f32 v[86:87], v[86:87], v[92:93] neg_lo:[0,1] neg_hi:[0,1]
    v_cvt_pk_bf16_f32 v70, v78, v79
    v_cvt_pk_bf16_f32 v71, v86, v87
    v_pk_mul_f32 v[78:79], v[38:39], v[18:19]
    v_pk_mul_f32 v[86:87], v[42:43], v[18:19]
    v_fract_f32 v79, v79
    v_fract_f32 v87, v87
    v_exp_f32 v82, v78
    v_exp_f32 v90, v86
    v_cos_f32 v80, v79
    v_cos_f32 v88, v87
    v_sin_f32 v81, v79
    v_sin_f32 v89, v87
    v_pk_mul_f32 v[78:79], v[80:81], v[82:83] op_sel_hi:[1,0]
    v_pk_mul_f32 v[86:87], v[88:89], v[90:91] op_sel_hi:[1,0]
    v_cvt_pk_bf16_f32 v60, v78, v79
    v_cvt_pk_bf16_f32 v61, v86, v87
    v_lshlrev_b32 v84, 16, v60
    v_lshlrev_b32 v92, 16, v61
    v_and_b32 v85, 0xffff0000, v60
    v_and_b32 v93, 0xffff0000, v61
    v_pk_add_f32 v[78:79], v[78:79], v[84:85] neg_lo:[0,1] neg_hi:[0,1]
    v_pk_add_f32 v[86:87], v[86:87], v[92:93] neg_lo:[0,1] neg_hi:[0,1]
    v_cvt_pk_bf16_f32 v72, v78, v79
    v_cvt_pk_bf16_f32 v73, v86, v87
    v_pk_mul_f32 v[78:79], v[30:31], v[20:21]
    v_pk_mul_f32 v[86:87], v[34:35], v[20:21]
    v_fract_f32 v79, v79
    v_fract_f32 v87, v87
    v_exp_f32 v82, v78
    v_exp_f32 v90, v86
    v_cos_f32 v80, v79
    v_cos_f32 v88, v87
    v_sin_f32 v81, v79
    v_sin_f32 v89, v87
    v_pk_mul_f32 v[78:79], v[80:81], v[82:83] op_sel_hi:[1,0]
    v_pk_mul_f32 v[86:87], v[88:89], v[90:91] op_sel_hi:[1,0]
    v_cvt_pk_bf16_f32 v62, v78, v79
    v_cvt_pk_bf16_f32 v63, v86, v87
    v_lshlrev_b32 v84, 16, v62
    v_lshlrev_b32 v92, 16, v63
    v_and_b32 v85, 0xffff0000, v62
    v_and_b32 v93, 0xffff0000, v63
    v_pk_add_f32 v[78:79], v[78:79], v[84:85] neg_lo:[0,1] neg_hi:[0,1]
    v_pk_add_f32 v[86:87], v[86:87], v[92:93] neg_lo:[0,1] neg_hi:[0,1]
    v_cvt_pk_bf16_f32 v74, v78, v79
    v_cvt_pk_bf16_f32 v75, v86, v87
    v_pk_mul_f32 v[78:79], v[38:39], v[20:21]
    v_pk_mul_f32 v[86:87], v[42:43], v[20:21]
    v_fract_f32 v79, v79
    v_fract_f32 v87, v87
    v_exp_f32 v82, v78
    v_exp_f32 v90, v86
    v_cos_f32 v80, v79
    v_cos_f32 v88, v87
    v_sin_f32 v81, v79
    v_sin_f32 v89, v87
    v_pk_mul_f32 v[78:79], v[80:81], v[82:83] op_sel_hi:[1,0]
    v_pk_mul_f32 v[86:87], v[88:89], v[90:91] op_sel_hi:[1,0]
    v_cvt_pk_bf16_f32 v64, v78, v79
    v_cvt_pk_bf16_f32 v65, v86, v87
    v_lshlrev_b32 v84, 16, v64
    v_lshlrev_b32 v92, 16, v65
    v_and_b32 v85, 0xffff0000, v64
    v_and_b32 v93, 0xffff0000, v65
    v_pk_add_f32 v[78:79], v[78:79], v[84:85] neg_lo:[0,1] neg_hi:[0,1]
    v_pk_add_f32 v[86:87], v[86:87], v[92:93] neg_lo:[0,1] neg_hi:[0,1]
    v_cvt_pk_bf16_f32 v76, v78, v79
    v_cvt_pk_bf16_f32 v77, v86, v87
    v_pk_mul_f32 v[78:79], v[30:31], v[22:23]
    v_pk_mul_f32 v[86:87], v[34:35], v[22:23]
    v_fract_f32 v79, v79
    v_fract_f32 v87, v87
    v_exp_f32 v82, v78
    v_exp_f32 v90, v86
    v_cos_f32 v80, v79
    v_cos_f32 v88, v87
    v_sin_f32 v81, v79
    v_sin_f32 v89, v87
    v_pk_mul_f32 v[78:79], v[80:81], v[82:83] op_sel_hi:[1,0]
    v_pk_mul_f32 v[86:87], v[88:89], v[90:91] op_sel_hi:[1,0]
    v_pk_mul_f32 v[84:85], v[78:79], v[32:33] op_sel_hi:[0,1]
    v_pk_mul_f32 v[92:93], v[86:87], v[36:37] op_sel_hi:[0,1]
    v_fma_f32 v78, -v79, v33, v84
    v_fma_f32 v86, -v87, v37, v92
    v_fma_f32 v79, -v79, v32, -v85
    v_fma_f32 v87, -v87, v36, -v93
    v_cvt_pk_bf16_f32 v46, v78, v79
    v_cvt_pk_bf16_f32 v47, v86, v87
    v_lshlrev_b32 v84, 16, v46
    v_lshlrev_b32 v92, 16, v47
    v_and_b32 v85, 0xffff0000, v46
    v_and_b32 v93, 0xffff0000, v47
    v_pk_add_f32 v[78:79], v[78:79], v[84:85] neg_lo:[0,1] neg_hi:[0,1]
    v_pk_add_f32 v[86:87], v[86:87], v[92:93] neg_lo:[0,1] neg_hi:[0,1]
    v_cvt_pk_bf16_f32 v50, v78, v79
    v_cvt_pk_bf16_f32 v51, v86, v87
    v_pk_mul_f32 v[78:79], v[38:39], v[22:23]
    v_pk_mul_f32 v[86:87], v[42:43], v[22:23]
    v_fract_f32 v79, v79
    v_fract_f32 v87, v87
    v_exp_f32 v82, v78
    v_exp_f32 v90, v86
    v_cos_f32 v80, v79
    v_cos_f32 v88, v87
    v_sin_f32 v81, v79
    v_sin_f32 v89, v87
    v_pk_mul_f32 v[78:79], v[80:81], v[82:83] op_sel_hi:[1,0]
    v_pk_mul_f32 v[86:87], v[88:89], v[90:91] op_sel_hi:[1,0]
    v_pk_mul_f32 v[84:85], v[78:79], v[40:41] op_sel_hi:[0,1]
    v_pk_mul_f32 v[92:93], v[86:87], v[44:45] op_sel_hi:[0,1]
    v_fma_f32 v78, -v79, v41, v84
    v_fma_f32 v86, -v87, v45, v92
    v_fma_f32 v79, -v79, v40, -v85
    v_fma_f32 v87, -v87, v44, -v93
    v_cvt_pk_bf16_f32 v48, v78, v79
    v_cvt_pk_bf16_f32 v49, v86, v87
    v_lshlrev_b32 v84, 16, v48
    v_lshlrev_b32 v92, 16, v49
    v_and_b32 v85, 0xffff0000, v48
    v_and_b32 v93, 0xffff0000, v49
    v_pk_add_f32 v[78:79], v[78:79], v[84:85] neg_lo:[0,1] neg_hi:[0,1]
    v_pk_add_f32 v[86:87], v[86:87], v[92:93] neg_lo:[0,1] neg_hi:[0,1]
    v_cvt_pk_bf16_f32 v52, v78, v79
    v_cvt_pk_bf16_f32 v53, v86, v87
    v_mfma_f32_16x16x32_bf16 a[0:3], v[46:49], v[54:57], a[0:3]
    v_mfma_f32_16x16x32_bf16 a[4:7], v[46:49], v[58:61], a[4:7]
    v_mfma_f32_16x16x32_bf16 a[8:11], v[46:49], v[62:65], a[8:11]
    v_mfma_f32_16x16x32_bf16 a[0:3], v[46:49], v[66:69], a[0:3]
    v_mfma_f32_16x16x32_bf16 a[4:7], v[46:49], v[70:73], a[4:7]
    v_mfma_f32_16x16x32_bf16 a[8:11], v[46:49], v[74:77], a[8:11]
    v_mfma_f32_16x16x32_bf16 a[0:3], v[50:53], v[54:57], a[0:3]
    v_mfma_f32_16x16x32_bf16 a[4:7], v[50:53], v[58:61], a[4:7]
    v_mfma_f32_16x16x32_bf16 a[8:11], v[50:53], v[62:65], a[8:11]
    ds_read_b128 v[30:33], v29 offset:768
    ds_read_b128 v[34:37], v29 offset:784
    ds_read_b128 v[38:41], v29 offset:800
    ds_read_b128 v[42:45], v29 offset:816
    s_waitcnt lgkmcnt(0)
    v_pk_mul_f32 v[78:79], v[30:31], v[16:17]
    v_pk_mul_f32 v[86:87], v[34:35], v[16:17]
    v_fract_f32 v79, v79
    v_fract_f32 v87, v87
    v_exp_f32 v82, v78
    v_exp_f32 v90, v86
    v_cos_f32 v80, v79
    v_cos_f32 v88, v87
    v_sin_f32 v81, v79
    v_sin_f32 v89, v87
    v_pk_mul_f32 v[78:79], v[80:81], v[82:83] op_sel_hi:[1,0]
    v_pk_mul_f32 v[86:87], v[88:89], v[90:91] op_sel_hi:[1,0]
    v_cvt_pk_bf16_f32 v54, v78, v79
    v_cvt_pk_bf16_f32 v55, v86, v87
    v_lshlrev_b32 v84, 16, v54
    v_lshlrev_b32 v92, 16, v55
    v_and_b32 v85, 0xffff0000, v54
    v_and_b32 v93, 0xffff0000, v55
    v_pk_add_f32 v[78:79], v[78:79], v[84:85] neg_lo:[0,1] neg_hi:[0,1]
    v_pk_add_f32 v[86:87], v[86:87], v[92:93] neg_lo:[0,1] neg_hi:[0,1]
    v_cvt_pk_bf16_f32 v66, v78, v79
    v_cvt_pk_bf16_f32 v67, v86, v87
    v_pk_mul_f32 v[78:79], v[38:39], v[16:17]
    v_pk_mul_f32 v[86:87], v[42:43], v[16:17]
    v_fract_f32 v79, v79
    v_fract_f32 v87, v87
    v_exp_f32 v82, v78
    v_exp_f32 v90, v86
    v_cos_f32 v80, v79
    v_cos_f32 v88, v87
    v_sin_f32 v81, v79
    v_sin_f32 v89, v87
    v_pk_mul_f32 v[78:79], v[80:81], v[82:83] op_sel_hi:[1,0]
    v_pk_mul_f32 v[86:87], v[88:89], v[90:91] op_sel_hi:[1,0]
    v_cvt_pk_bf16_f32 v56, v78, v79
    v_cvt_pk_bf16_f32 v57, v86, v87
    v_lshlrev_b32 v84, 16, v56
    v_lshlrev_b32 v92, 16, v57
    v_and_b32 v85, 0xffff0000, v56
    v_and_b32 v93, 0xffff0000, v57
    v_pk_add_f32 v[78:79], v[78:79], v[84:85] neg_lo:[0,1] neg_hi:[0,1]
    v_pk_add_f32 v[86:87], v[86:87], v[92:93] neg_lo:[0,1] neg_hi:[0,1]
    v_cvt_pk_bf16_f32 v68, v78, v79
    v_cvt_pk_bf16_f32 v69, v86, v87
    v_pk_mul_f32 v[78:79], v[30:31], v[18:19]
    v_pk_mul_f32 v[86:87], v[34:35], v[18:19]
    v_fract_f32 v79, v79
    v_fract_f32 v87, v87
    v_exp_f32 v82, v78
    v_exp_f32 v90, v86
    v_cos_f32 v80, v79
    v_cos_f32 v88, v87
    v_sin_f32 v81, v79
    v_sin_f32 v89, v87
    v_pk_mul_f32 v[78:79], v[80:81], v[82:83] op_sel_hi:[1,0]
    v_pk_mul_f32 v[86:87], v[88:89], v[90:91] op_sel_hi:[1,0]
    v_cvt_pk_bf16_f32 v58, v78, v79
    v_cvt_pk_bf16_f32 v59, v86, v87
    v_lshlrev_b32 v84, 16, v58
    v_lshlrev_b32 v92, 16, v59
    v_and_b32 v85, 0xffff0000, v58
    v_and_b32 v93, 0xffff0000, v59
    v_pk_add_f32 v[78:79], v[78:79], v[84:85] neg_lo:[0,1] neg_hi:[0,1]
    v_pk_add_f32 v[86:87], v[86:87], v[92:93] neg_lo:[0,1] neg_hi:[0,1]
    v_cvt_pk_bf16_f32 v70, v78, v79
    v_cvt_pk_bf16_f32 v71, v86, v87
    v_pk_mul_f32 v[78:79], v[38:39], v[18:19]
    v_pk_mul_f32 v[86:87], v[42:43], v[18:19]
    v_fract_f32 v79, v79
    v_fract_f32 v87, v87
    v_exp_f32 v82, v78
    v_exp_f32 v90, v86
    v_cos_f32 v80, v79
    v_cos_f32 v88, v87
    v_sin_f32 v81, v79
    v_sin_f32 v89, v87
    v_pk_mul_f32 v[78:79], v[80:81], v[82:83] op_sel_hi:[1,0]
    v_pk_mul_f32 v[86:87], v[88:89], v[90:91] op_sel_hi:[1,0]
    v_cvt_pk_bf16_f32 v60, v78, v79
    v_cvt_pk_bf16_f32 v61, v86, v87
    v_lshlrev_b32 v84, 16, v60
    v_lshlrev_b32 v92, 16, v61
    v_and_b32 v85, 0xffff0000, v60
    v_and_b32 v93, 0xffff0000, v61
    v_pk_add_f32 v[78:79], v[78:79], v[84:85] neg_lo:[0,1] neg_hi:[0,1]
    v_pk_add_f32 v[86:87], v[86:87], v[92:93] neg_lo:[0,1] neg_hi:[0,1]
    v_cvt_pk_bf16_f32 v72, v78, v79
    v_cvt_pk_bf16_f32 v73, v86, v87
    v_pk_mul_f32 v[78:79], v[30:31], v[20:21]
    v_pk_mul_f32 v[86:87], v[34:35], v[20:21]
    v_fract_f32 v79, v79
    v_fract_f32 v87, v87
    v_exp_f32 v82, v78
    v_exp_f32 v90, v86
    v_cos_f32 v80, v79
    v_cos_f32 v88, v87
    v_sin_f32 v81, v79
    v_sin_f32 v89, v87
    v_pk_mul_f32 v[78:79], v[80:81], v[82:83] op_sel_hi:[1,0]
    v_pk_mul_f32 v[86:87], v[88:89], v[90:91] op_sel_hi:[1,0]
    v_cvt_pk_bf16_f32 v62, v78, v79
    v_cvt_pk_bf16_f32 v63, v86, v87
    v_lshlrev_b32 v84, 16, v62
    v_lshlrev_b32 v92, 16, v63
    v_and_b32 v85, 0xffff0000, v62
    v_and_b32 v93, 0xffff0000, v63
    v_pk_add_f32 v[78:79], v[78:79], v[84:85] neg_lo:[0,1] neg_hi:[0,1]
    v_pk_add_f32 v[86:87], v[86:87], v[92:93] neg_lo:[0,1] neg_hi:[0,1]
    v_cvt_pk_bf16_f32 v74, v78, v79
    v_cvt_pk_bf16_f32 v75, v86, v87
    v_pk_mul_f32 v[78:79], v[38:39], v[20:21]
    v_pk_mul_f32 v[86:87], v[42:43], v[20:21]
    v_fract_f32 v79, v79
    v_fract_f32 v87, v87
    v_exp_f32 v82, v78
    v_exp_f32 v90, v86
    v_cos_f32 v80, v79
    v_cos_f32 v88, v87
    v_sin_f32 v81, v79
    v_sin_f32 v89, v87
    v_pk_mul_f32 v[78:79], v[80:81], v[82:83] op_sel_hi:[1,0]
    v_pk_mul_f32 v[86:87], v[88:89], v[90:91] op_sel_hi:[1,0]
    v_cvt_pk_bf16_f32 v64, v78, v79
    v_cvt_pk_bf16_f32 v65, v86, v87
    v_lshlrev_b32 v84, 16, v64
    v_lshlrev_b32 v92, 16, v65
    v_and_b32 v85, 0xffff0000, v64
    v_and_b32 v93, 0xffff0000, v65
    v_pk_add_f32 v[78:79], v[78:79], v[84:85] neg_lo:[0,1] neg_hi:[0,1]
    v_pk_add_f32 v[86:87], v[86:87], v[92:93] neg_lo:[0,1] neg_hi:[0,1]
    v_cvt_pk_bf16_f32 v76, v78, v79
    v_cvt_pk_bf16_f32 v77, v86, v87
    v_pk_mul_f32 v[78:79], v[30:31], v[22:23]
    v_pk_mul_f32 v[86:87], v[34:35], v[22:23]
    v_fract_f32 v79, v79
    v_fract_f32 v87, v87
    v_exp_f32 v82, v78
    v_exp_f32 v90, v86
    v_cos_f32 v80, v79
    v_cos_f32 v88, v87
    v_sin_f32 v81, v79
    v_sin_f32 v89, v87
    v_pk_mul_f32 v[78:79], v[80:81], v[82:83] op_sel_hi:[1,0]
    v_pk_mul_f32 v[86:87], v[88:89], v[90:91] op_sel_hi:[1,0]
    v_pk_mul_f32 v[84:85], v[78:79], v[32:33] op_sel_hi:[0,1]
    v_pk_mul_f32 v[92:93], v[86:87], v[36:37] op_sel_hi:[0,1]
    v_fma_f32 v78, -v79, v33, v84
    v_fma_f32 v86, -v87, v37, v92
    v_fma_f32 v79, -v79, v32, -v85
    v_fma_f32 v87, -v87, v36, -v93
    v_cvt_pk_bf16_f32 v46, v78, v79
    v_cvt_pk_bf16_f32 v47, v86, v87
    v_lshlrev_b32 v84, 16, v46
    v_lshlrev_b32 v92, 16, v47
    v_and_b32 v85, 0xffff0000, v46
    v_and_b32 v93, 0xffff0000, v47
    v_pk_add_f32 v[78:79], v[78:79], v[84:85] neg_lo:[0,1] neg_hi:[0,1]
    v_pk_add_f32 v[86:87], v[86:87], v[92:93] neg_lo:[0,1] neg_hi:[0,1]
    v_cvt_pk_bf16_f32 v50, v78, v79
    v_cvt_pk_bf16_f32 v51, v86, v87
    v_pk_mul_f32 v[78:79], v[38:39], v[22:23]
    v_pk_mul_f32 v[86:87], v[42:43], v[22:23]
    v_fract_f32 v79, v79
    v_fract_f32 v87, v87
    v_exp_f32 v82, v78
    v_exp_f32 v90, v86
    v_cos_f32 v80, v79
    v_cos_f32 v88, v87
    v_sin_f32 v81, v79
    v_sin_f32 v89, v87
    v_pk_mul_f32 v[78:79], v[80:81], v[82:83] op_sel_hi:[1,0]
    v_pk_mul_f32 v[86:87], v[88:89], v[90:91] op_sel_hi:[1,0]
    v_pk_mul_f32 v[84:85], v[78:79], v[40:41] op_sel_hi:[0,1]
    v_pk_mul_f32 v[92:93], v[86:87], v[44:45] op_sel_hi:[0,1]
    v_fma_f32 v78, -v79, v41, v84
    v_fma_f32 v86, -v87, v45, v92
    v_fma_f32 v79, -v79, v40, -v85
    v_fma_f32 v87, -v87, v44, -v93
    v_cvt_pk_bf16_f32 v48, v78, v79
    v_cvt_pk_bf16_f32 v49, v86, v87
    v_lshlrev_b32 v84, 16, v48
    v_lshlrev_b32 v92, 16, v49
    v_and_b32 v85, 0xffff0000, v48
    v_and_b32 v93, 0xffff0000, v49
    v_pk_add_f32 v[78:79], v[78:79], v[84:85] neg_lo:[0,1] neg_hi:[0,1]
    v_pk_add_f32 v[86:87], v[86:87], v[92:93] neg_lo:[0,1] neg_hi:[0,1]
    v_cvt_pk_bf16_f32 v52, v78, v79
    v_cvt_pk_bf16_f32 v53, v86, v87
    v_mfma_f32_16x16x32_bf16 a[0:3], v[46:49], v[54:57], a[0:3]
    v_mfma_f32_16x16x32_bf16 a[4:7], v[46:49], v[58:61], a[4:7]
    v_mfma_f32_16x16x32_bf16 a[8:11], v[46:49], v[62:65], a[8:11]
    v_mfma_f32_16x16x32_bf16 a[0:3], v[46:49], v[66:69], a[0:3]
    v_mfma_f32_16x16x32_bf16 a[4:7], v[46:49], v[70:73], a[4:7]
    v_mfma_f32_16x16x32_bf16 a[8:11], v[46:49], v[74:77], a[8:11]
    v_mfma_f32_16x16x32_bf16 a[0:3], v[50:53], v[54:57], a[0:3]
    v_mfma_f32_16x16x32_bf16 a[4:7], v[50:53], v[58:61], a[4:7]
    v_mfma_f32_16x16x32_bf16 a[8:11], v[50:53], v[62:65], a[8:11]
    s_nop 5
    v_accvgpr_read_b32 v54, a0
    v_accvgpr_read_b32 v55, a1
    v_accvgpr_read_b32 v56, a2
    v_accvgpr_read_b32 v57, a3
    v_accvgpr_read_b32 v58, a4
    v_accvgpr_read_b32 v59, a5
    v_accvgpr_read_b32 v60, a6
    v_accvgpr_read_b32 v61, a7
    v_accvgpr_read_b32 v62, a8
    v_accvgpr_read_b32 v63, a9
    v_accvgpr_read_b32 v64, a10
    v_accvgpr_read_b32 v65, a11
    v_lshrrev_b32 v30, 6, v0
    s_nop 0
    v_readfirstlane_b32 s16, v30
    s_and_b32 s16, s16, 1
    s_cmp_eq_u32 s16, 0
    s_cbranch_scc1 KG_even
    s_nop 3
    v_lshlrev_b32 v31, 2, v2
    v_mov_b32 v32, 1
    ds_write_b128 v9, v[54:57] offset:0
    ds_write_b128 v9, v[58:61] offset:1024
    ds_write_b128 v9, v[62:65] offset:2048
    s_waitcnt lgkmcnt(0)
    ds_write_b32 v31, v32 offset:42500
    s_branch KG_join
KG_even:
    v_lshlrev_b32 v31, 2, v2
KG_spin1:
    ds_read_b32 v32, v31 offset:42500
    s_waitcnt lgkmcnt(0)
    v_readfirstlane_b32 s16, v32
    s_cmp_eq_u32 s16, 0
    s_cbranch_scc1 KG_spin1
    ds_read_b128 v[30:33], v9 offset:0
    ds_read_b128 v[34:37], v9 offset:1024
    ds_read_b128 v[38:41], v9 offset:2048
    s_waitcnt lgkmcnt(0)
    v_pk_add_f32 v[54:55], v[54:55], v[30:31]
    v_pk_add_f32 v[56:57], v[56:57], v[32:33]
    v_pk_add_f32 v[58:59], v[58:59], v[34:35]
    v_pk_add_f32 v[60:61], v[60:61], v[36:37]
    v_pk_add_f32 v[62:63], v[62:63], v[38:39]
    v_pk_add_f32 v[64:65], v[64:65], v[40:41]
    ds_write_b32 v25, v54 offset:0
    ds_write_b32 v25, v55 offset:36
    ds_write_b32 v25, v56 offset:72
    ds_write_b32 v25, v57 offset:108
    ds_write_b32 v26, v58 offset:0
    ds_write_b32 v26, v59 offset:36
    ds_write_b32 v26, v60 offset:72
    ds_write_b32 v26, v61 offset:108
    s_mov_b64 exec, s[60:61]
    ds_write_b32 v27, v62 offset:0
    ds_write_b32 v27, v63 offset:36
    ds_write_b32 v27, v64 offset:72
    ds_write_b32 v27, v65 offset:108
    s_waitcnt lgkmcnt(0)
    s_mov_b64 exec, 1
    v_mov_b32 v31, 0
    v_mov_b32 v32, 1
    ds_add_u32 v31, v32 offset:42508
    s_mov_b64 exec, -1
KG_join:
    v_mov_b32 v60, v0
    v_lshlrev_b32 v61, 1, v0
    v_add_u32 v61, 0x100, v61
    v_lshlrev_b32 v62, 2, v0
    v_cmp_gt_u32 vcc, 128, v0
    s_nop 1
    v_cndmask_b32 v61, v62, v61, vcc
    v_lshlrev_b32 v62, 3, v0
    v_add_u32 v62, 0x400, v62
    v_min_u32 v62, 0x800, v62
    v_lshrrev_b32 v52, 3, v60
    v_add_lshl_u32 v52, v52, v60, 2
    v_lshrrev_b32 v53, 3, v61
    v_add_lshl_u32 v53, v53, v61, 2
    v_lshrrev_b32 v54, 3, v62
    v_add_lshl_u32 v54, v54, v62, 2
    v_add_u32 v52, 47104, v52
    v_add_u32 v53, 47104, v53
    v_add_u32 v54, 47104, v54
    v_mov_b32 v31, 0
KG_spin2:
    ds_read_b32 v32, v31 offset:42508
    s_waitcnt lgkmcnt(0)
    v_readfirstlane_b32 s16, v32
    s_cmp_lt_u32 s16, 2
    s_cbranch_scc1 KG_spin2
    v_mov_b32 v31, 72960
    ds_read_b128 v[32:35], v31
    ds_read_b32 v68, v52 offset:0
    ds_read_b32 v69, v53 offset:0
    ds_read_b32 v70, v54 offset:0
    ds_read_b32 v72, v52 offset:9856
    ds_read_b32 v73, v53 offset:9856
    ds_read_b32 v74, v54 offset:9856
    s_mul_i32 s16, s3, 6144
    v_lshlrev_b32 v30, 2, v0
    v_add_u32 v30, s16, v30
    s_waitcnt lgkmcnt(0)
    v_add_f32 v32, v32, v33
    v_add_f32 v34, v34, v35
    v_frexp_exp_i32_f32 v32, v32
    v_frexp_exp_i32_f32 v34, v34
    v_sub_u32 v32, 14, v32
    v_sub_u32 v34, 14, v34
    v_ldexp_f32 v68, v68, v32
    v_cvt_f16_f32 v68, v68
    v_ldexp_f32 v69, v69, v32
    v_cvt_f16_f32 v69, v69
    v_ldexp_f32 v70, v70, v32
    v_cvt_f16_f32 v70, v70
    v_ldexp_f32 v72, v72, v34
    v_cvt_f16_f32 v72, v72
    v_ldexp_f32 v73, v73, v34
    v_cvt_f16_f32 v73, v73
    v_ldexp_f32 v74, v74, v34
    v_cvt_f16_f32 v74, v74
    v_sub_u32 v32, 0, v32
    v_sub_u32 v34, 0, v34
    v_ldexp_f32 v36, 1.0, v32
    v_ldexp_f32 v37, 1.0, v34
    s_lshl_b32 s16, s3, 3
    s_add_u32 s16, s16, 0x10000
    v_mov_b32 v31, s16
    v_cmp_eq_u32 vcc, 0, v0
    s_and_saveexec_b64 s[18:19], vcc
    s_cbranch_execz KG_nosc
    buffer_store_dwordx2 v[36:37], v31, s[56:59], 0 offen sc1
KG_nosc:
    s_mov_b64 exec, s[18:19]
    s_movk_i32 s16, 3072
    buffer_store_dword v68, v30, s[40:43], 0 offen offset:0 sc1
    buffer_store_dword v69, v30, s[40:43], 0 offen offset:1024 sc1
    buffer_store_dword v70, v30, s[40:43], 0 offen offset:2048 sc1
    buffer_store_dword v72, v30, s[40:43], s16 offen offset:0 sc1
    buffer_store_dword v73, v30, s[40:43], s16 offen offset:1024 sc1
    buffer_store_dword v74, v30, s[40:43], s16 offen offset:2048 sc1
    v_and_b32 v80, 15, v0
    v_bfe_u32 v81, v0, 4, 2
    v_lshrrev_b32 v82, 7, v0
    v_bfe_u32 v83, v0, 6, 1
    v_mul_u32_u24 v82, 21248, v82
    v_lshlrev_b32 v83, 8, v83
    v_sub_u32 v82, v82, v83
    v_sub_u32 v84, 3, v80
    v_and_b32 v84, 3, v84
    v_mul_u32_u24 v85, 4160, v84
    v_add_u32 v86, v80, v84
    v_lshlrev_b32 v87, 3, v81
    v_sub_u32 v86, v87, v86
    v_lshlrev_b32 v86, 1, v86
    v_add3_u32 v86, v86, v85, v82
    v_add_u32 v1, 302, v86
    v_lshlrev_b32 v86, 5, v80
    v_lshl_add_u32 v86, v81, 4, v86
    v_add_u32 v86, v86, v82
    v_add_u32 v2, 16672, v86
    v_lshrrev_b32 v86, 6, v0
    v_mul_u32_u24 v86, 5120, v86
    v_mul_u32_u24 v87, 80, v80
    v_lshlrev_b32 v85, 4, v81
    v_add3_u32 v3, v86, v87, v85
    v_add_u32 v3, 43008, v3
    v_accvgpr_write_b32 a0, 0
    v_accvgpr_write_b32 a1, 0
    v_accvgpr_write_b32 a2, 0
    v_accvgpr_write_b32 a3, 0
    v_accvgpr_write_b32 a4, 0
    v_accvgpr_write_b32 a5, 0
    v_accvgpr_write_b32 a6, 0
    v_accvgpr_write_b32 a7, 0
    v_accvgpr_write_b32 a8, 0
    v_accvgpr_write_b32 a9, 0
    v_accvgpr_write_b32 a10, 0
    v_accvgpr_write_b32 a11, 0
    v_accvgpr_write_b32 a12, 0
    v_accvgpr_write_b32 a13, 0
    v_accvgpr_write_b32 a14, 0
    v_accvgpr_write_b32 a15, 0
    v_accvgpr_write_b32 a16, 0
    v_accvgpr_write_b32 a17, 0
    v_accvgpr_write_b32 a18, 0
    v_accvgpr_write_b32 a19, 0
    v_accvgpr_write_b32 a20, 0
    v_accvgpr_write_b32 a21, 0
    v_accvgpr_write_b32 a22, 0
    v_accvgpr_write_b32 a23, 0
    v_accvgpr_write_b32 a24, 0
    v_accvgpr_write_b32 a25, 0
    v_accvgpr_write_b32 a26, 0
    v_accvgpr_write_b32 a27, 0
    v_accvgpr_write_b32 a28, 0
    v_accvgpr_write_b32 a29, 0
    v_accvgpr_write_b32 a30, 0
    v_accvgpr_write_b32 a31, 0
    s_barrier
    ds_read_b128 v[36:39], v2 offset:448
    ds_read_b64 v[4:5], v1 offset:3776
    ds_read_b64 v[6:7], v1 offset:3784
    ds_read_b64 v[8:9], v1 offset:3264
    ds_read_b64 v[10:11], v1 offset:3272
    ds_read_b64 v[12:13], v1 offset:2752
    ds_read_b64 v[14:15], v1 offset:2760
    ds_read_b64 v[16:17], v1 offset:2240
    ds_read_b64 v[18:19], v1 offset:2248
    ds_read_b128 v[40:43], v2 offset:960
    ds_read_b128 v[44:47], v2 offset:1472
    ds_read_b128 v[48:51], v2 offset:1984
    ds_read_b128 v[52:55], v2 offset:2496
    ds_read_b128 v[56:59], v2 offset:3008
    ds_read_b128 v[60:63], v2 offset:3520
    ds_read_b128 v[64:67], v2 offset:4032
    s_waitcnt lgkmcnt(13)
    v_mfma_f32_16x16x32_bf16 a[0:3], v[4:7], v[36:39], a[0:3]
    ds_read_b64 v[20:21], v1 offset:3712
    s_waitcnt lgkmcnt(12)
    v_mfma_f32_16x16x32_bf16 a[4:7], v[8:11], v[36:39], a[4:7]
    ds_read_b64 v[22:23], v1 offset:3720
    s_waitcnt lgkmcnt(11)
    v_mfma_f32_16x16x32_bf16 a[8:11], v[12:15], v[36:39], a[8:11]
    ds_read_b64 v[24:25], v1 offset:3200
    s_waitcnt lgkmcnt(10)
    v_mfma_f32_16x16x32_bf16 a[12:15], v[16:19], v[36:39], a[12:15]
    ds_read_b64 v[26:27], v1 offset:3208
    ds_read_b128 v[36:39], v2 offset:384
    s_waitcnt lgkmcnt(11)
    v_mfma_f32_16x16x32_bf16 a[4:7], v[4:7], v[40:43], a[4:7]
    ds_read_b64 v[28:29], v1 offset:2688
    v_mfma_f32_16x16x32_bf16 a[8:11], v[8:11], v[40:43], a[8:11]
    ds_read_b64 v[30:31], v1 offset:2696
    v_mfma_f32_16x16x32_bf16 a[12:15], v[12:15], v[40:43], a[12:15]
    ds_read_b64 v[32:33], v1 offset:2176
    v_mfma_f32_16x16x32_bf16 a[16:19], v[16:19], v[40:43], a[16:19]
    ds_read_b64 v[34:35], v1 offset:2184
    ds_read_b128 v[40:43], v2 offset:896
    s_waitcnt lgkmcnt(15)
    v_mfma_f32_16x16x32_bf16 a[8:11], v[4:7], v[44:47], a[8:11]
    v_mfma_f32_16x16x32_bf16 a[12:15], v[8:11], v[44:47], a[12:15]
    v_mfma_f32_16x16x32_bf16 a[16:19], v[12:15], v[44:47], a[16:19]
    v_mfma_f32_16x16x32_bf16 a[20:23], v[16:19], v[44:47], a[20:23]
    ds_read_b128 v[44:47], v2 offset:1408
    s_waitcnt lgkmcnt(15)
    v_mfma_f32_16x16x32_bf16 a[12:15], v[4:7], v[48:51], a[12:15]
    v_mfma_f32_16x16x32_bf16 a[16:19], v[8:11], v[48:51], a[16:19]
    v_mfma_f32_16x16x32_bf16 a[20:23], v[12:15], v[48:51], a[20:23]
    v_mfma_f32_16x16x32_bf16 a[24:27], v[16:19], v[48:51], a[24:27]
    ds_read_b128 v[48:51], v2 offset:1920
    s_waitcnt lgkmcnt(15)
    v_mfma_f32_16x16x32_bf16 a[16:19], v[4:7], v[52:55], a[16:19]
    v_mfma_f32_16x16x32_bf16 a[20:23], v[8:11], v[52:55], a[20:23]
    v_mfma_f32_16x16x32_bf16 a[24:27], v[12:15], v[52:55], a[24:27]
    v_mfma_f32_16x16x32_bf16 a[28:31], v[16:19], v[52:55], a[28:31]
    ds_read_b128 v[52:55], v2 offset:2432
    s_waitcnt lgkmcnt(15)
    v_mfma_f32_16x16x32_bf16 a[20:23], v[4:7], v[56:59], a[20:23]
    v_mfma_f32_16x16x32_bf16 a[24:27], v[8:11], v[56:59], a[24:27]
    v_mfma_f32_16x16x32_bf16 a[28:31], v[12:15], v[56:59], a[28:31]
    ds_read_b128 v[56:59], v2 offset:2944
    s_waitcnt lgkmcnt(15)
    v_mfma_f32_16x16x32_bf16 a[24:27], v[4:7], v[60:63], a[24:27]
    v_mfma_f32_16x16x32_bf16 a[28:31], v[8:11], v[60:63], a[28:31]
    ds_read_b128 v[60:63], v2 offset:3456
    s_waitcnt lgkmcnt(15)
    v_mfma_f32_16x16x32_bf16 a[28:31], v[4:7], v[64:67], a[28:31]
    ds_read_b128 v[64:67], v2 offset:3968
    s_waitcnt lgkmcnt(11)
    v_mfma_f32_16x16x32_bf16 a[0:3], v[20:23], v[36:39], a[0:3]
    ds_read_b64 v[4:5], v1 offset:3648
    v_mfma_f32_16x16x32_bf16 a[4:7], v[24:27], v[36:39], a[4:7]
    ds_read_b64 v[6:7], v1 offset:3656
    s_waitcnt lgkmcnt(11)
    v_mfma_f32_16x16x32_bf16 a[8:11], v[28:31], v[36:39], a[8:11]
    ds_read_b64 v[8:9], v1 offset:3136
    s_waitcnt lgkmcnt(10)
    v_mfma_f32_16x16x32_bf16 a[12:15], v[32:35], v[36:39], a[12:15]
    ds_read_b64 v[10:11], v1 offset:3144
    ds_read_b128 v[36:39], v2 offset:320
    s_waitcnt lgkmcnt(11)
    v_mfma_f32_16x16x32_bf16 a[4:7], v[20:23], v[40:43], a[4:7]
    ds_read_b64 v[12:13], v1 offset:2624
    v_mfma_f32_16x16x32_bf16 a[8:11], v[24:27], v[40:43], a[8:11]
    ds_read_b64 v[14:15], v1 offset:2632
    v_mfma_f32_16x16x32_bf16 a[12:15], v[28:31], v[40:43], a[12:15]
    ds_read_b64 v[16:17], v1 offset:2112
    v_mfma_f32_16x16x32_bf16 a[16:19], v[32:35], v[40:43], a[16:19]
    ds_read_b64 v[18:19], v1 offset:2120
    ds_read_b128 v[40:43], v2 offset:832
    s_waitcnt lgkmcnt(15)
    v_mfma_f32_16x16x32_bf16 a[8:11], v[20:23], v[44:47], a[8:11]
    v_mfma_f32_16x16x32_bf16 a[12:15], v[24:27], v[44:47], a[12:15]
    v_mfma_f32_16x16x32_bf16 a[16:19], v[28:31], v[44:47], a[16:19]
    v_mfma_f32_16x16x32_bf16 a[20:23], v[32:35], v[44:47], a[20:23]
    ds_read_b128 v[44:47], v2 offset:1344
    s_waitcnt lgkmcnt(15)
    v_mfma_f32_16x16x32_bf16 a[12:15], v[20:23], v[48:51], a[12:15]
    v_mfma_f32_16x16x32_bf16 a[16:19], v[24:27], v[48:51], a[16:19]
    v_mfma_f32_16x16x32_bf16 a[20:23], v[28:31], v[48:51], a[20:23]
    v_mfma_f32_16x16x32_bf16 a[24:27], v[32:35], v[48:51], a[24:27]
    ds_read_b128 v[48:51], v2 offset:1856
    s_waitcnt lgkmcnt(15)
    v_mfma_f32_16x16x32_bf16 a[16:19], v[20:23], v[52:55], a[16:19]
    v_mfma_f32_16x16x32_bf16 a[20:23], v[24:27], v[52:55], a[20:23]
    v_mfma_f32_16x16x32_bf16 a[24:27], v[28:31], v[52:55], a[24:27]
    v_mfma_f32_16x16x32_bf16 a[28:31], v[32:35], v[52:55], a[28:31]
    ds_read_b128 v[52:55], v2 offset:2368
    s_waitcnt lgkmcnt(15)
    v_mfma_f32_16x16x32_bf16 a[20:23], v[20:23], v[56:59], a[20:23]
    v_mfma_f32_16x16x32_bf16 a[24:27], v[24:27], v[56:59], a[24:27]
    v_mfma_f32_16x16x32_bf16 a[28:31], v[28:31], v[56:59], a[28:31]
    ds_read_b128 v[56:59], v2 offset:2880
    s_waitcnt lgkmcnt(15)
    v_mfma_f32_16x16x32_bf16 a[24:27], v[20:23], v[60:63], a[24:27]
    v_mfma_f32_16x16x32_bf16 a[28:31], v[24:27], v[60:63], a[28:31]
    ds_read_b128 v[60:63], v2 offset:3392
    s_waitcnt lgkmcnt(15)
    v_mfma_f32_16x16x32_bf16 a[28:31], v[20:23], v[64:67], a[28:31]
    ds_read_b128 v[64:67], v2 offset:3904
    s_waitcnt lgkmcnt(11)
    v_mfma_f32_16x16x32_bf16 a[0:3], v[4:7], v[36:39], a[0:3]
    ds_read_b64 v[20:21], v1 offset:3584
    v_mfma_f32_16x16x32_bf16 a[4:7], v[8:11], v[36:39], a[4:7]
    ds_read_b64 v[22:23], v1 offset:3592
    s_waitcnt lgkmcnt(11)
    v_mfma_f32_16x16x32_bf16 a[8:11], v[12:15], v[36:39], a[8:11]
    ds_read_b64 v[24:25], v1 offset:3072
    s_waitcnt lgkmcnt(10)
    v_mfma_f32_16x16x32_bf16 a[12:15], v[16:19], v[36:39], a[12:15]
    ds_read_b64 v[26:27], v1 offset:3080
    ds_read_b128 v[36:39], v2 offset:256
    s_waitcnt lgkmcnt(11)
    v_mfma_f32_16x16x32_bf16 a[4:7], v[4:7], v[40:43], a[4:7]
    ds_read_b64 v[28:29], v1 offset:2560
    v_mfma_f32_16x16x32_bf16 a[8:11], v[8:11], v[40:43], a[8:11]
    ds_read_b64 v[30:31], v1 offset:2568
    v_mfma_f32_16x16x32_bf16 a[12:15], v[12:15], v[40:43], a[12:15]
    ds_read_b64 v[32:33], v1 offset:2048
    v_mfma_f32_16x16x32_bf16 a[16:19], v[16:19], v[40:43], a[16:19]
    ds_read_b64 v[34:35], v1 offset:2056
    ds_read_b128 v[40:43], v2 offset:768
    s_waitcnt lgkmcnt(15)
    v_mfma_f32_16x16x32_bf16 a[8:11], v[4:7], v[44:47], a[8:11]
    v_mfma_f32_16x16x32_bf16 a[12:15], v[8:11], v[44:47], a[12:15]
    v_mfma_f32_16x16x32_bf16 a[16:19], v[12:15], v[44:47], a[16:19]
    v_mfma_f32_16x16x32_bf16 a[20:23], v[16:19], v[44:47], a[20:23]
    ds_read_b128 v[44:47], v2 offset:1280
    s_waitcnt lgkmcnt(15)
    v_mfma_f32_16x16x32_bf16 a[12:15], v[4:7], v[48:51], a[12:15]
    v_mfma_f32_16x16x32_bf16 a[16:19], v[8:11], v[48:51], a[16:19]
    v_mfma_f32_16x16x32_bf16 a[20:23], v[12:15], v[48:51], a[20:23]
    v_mfma_f32_16x16x32_bf16 a[24:27], v[16:19], v[48:51], a[24:27]
    ds_read_b128 v[48:51], v2 offset:1792
    s_waitcnt lgkmcnt(15)
    v_mfma_f32_16x16x32_bf16 a[16:19], v[4:7], v[52:55], a[16:19]
    v_mfma_f32_16x16x32_bf16 a[20:23], v[8:11], v[52:55], a[20:23]
    v_mfma_f32_16x16x32_bf16 a[24:27], v[12:15], v[52:55], a[24:27]
    v_mfma_f32_16x16x32_bf16 a[28:31], v[16:19], v[52:55], a[28:31]
    ds_read_b128 v[52:55], v2 offset:2304
    s_waitcnt lgkmcnt(15)
    v_mfma_f32_16x16x32_bf16 a[20:23], v[4:7], v[56:59], a[20:23]
    v_mfma_f32_16x16x32_bf16 a[24:27], v[8:11], v[56:59], a[24:27]
    v_mfma_f32_16x16x32_bf16 a[28:31], v[12:15], v[56:59], a[28:31]
    ds_read_b128 v[56:59], v2 offset:2816
    s_waitcnt lgkmcnt(15)
    v_mfma_f32_16x16x32_bf16 a[24:27], v[4:7], v[60:63], a[24:27]
    v_mfma_f32_16x16x32_bf16 a[28:31], v[8:11], v[60:63], a[28:31]
    ds_read_b128 v[60:63], v2 offset:3328
    s_waitcnt lgkmcnt(15)
    v_mfma_f32_16x16x32_bf16 a[28:31], v[4:7], v[64:67], a[28:31]
    ds_read_b128 v[64:67], v2 offset:3840
    s_waitcnt lgkmcnt(11)
    v_mfma_f32_16x16x32_bf16 a[0:3], v[20:23], v[36:39], a[0:3]
    v_mfma_f32_16x16x32_bf16 a[4:7], v[24:27], v[36:39], a[4:7]
    s_waitcnt lgkmcnt(9)
    v_mfma_f32_16x16x32_bf16 a[8:11], v[28:31], v[36:39], a[8:11]
    s_waitcnt lgkmcnt(7)
    v_mfma_f32_16x16x32_bf16 a[12:15], v[32:35], v[36:39], a[12:15]
    s_waitcnt lgkmcnt(6)
    v_mfma_f32_16x16x32_bf16 a[4:7], v[20:23], v[40:43], a[4:7]
    v_mfma_f32_16x16x32_bf16 a[8:11], v[24:27], v[40:43], a[8:11]
    v_mfma_f32_16x16x32_bf16 a[12:15], v[28:31], v[40:43], a[12:15]
    v_mfma_f32_16x16x32_bf16 a[16:19], v[32:35], v[40:43], a[16:19]
    s_waitcnt lgkmcnt(5)
    v_mfma_f32_16x16x32_bf16 a[8:11], v[20:23], v[44:47], a[8:11]
    v_mfma_f32_16x16x32_bf16 a[12:15], v[24:27], v[44:47], a[12:15]
    v_mfma_f32_16x16x32_bf16 a[16:19], v[28:31], v[44:47], a[16:19]
    v_mfma_f32_16x16x32_bf16 a[20:23], v[32:35], v[44:47], a[20:23]
    s_waitcnt lgkmcnt(4)
    v_mfma_f32_16x16x32_bf16 a[12:15], v[20:23], v[48:51], a[12:15]
    v_mfma_f32_16x16x32_bf16 a[16:19], v[24:27], v[48:51], a[16:19]
    v_mfma_f32_16x16x32_bf16 a[20:23], v[28:31], v[48:51], a[20:23]
    v_mfma_f32_16x16x32_bf16 a[24:27], v[32:35], v[48:51], a[24:27]
    s_waitcnt lgkmcnt(3)
    v_mfma_f32_16x16x32_bf16 a[16:19], v[20:23], v[52:55], a[16:19]
    v_mfma_f32_16x16x32_bf16 a[20:23], v[24:27], v[52:55], a[20:23]
    v_mfma_f32_16x16x32_bf16 a[24:27], v[28:31], v[52:55], a[24:27]
    v_mfma_f32_16x16x32_bf16 a[28:31], v[32:35], v[52:55], a[28:31]
    s_waitcnt lgkmcnt(2)
    v_mfma_f32_16x16x32_bf16 a[20:23], v[20:23], v[56:59], a[20:23]
    v_mfma_f32_16x16x32_bf16 a[24:27], v[24:27], v[56:59], a[24:27]
    v_mfma_f32_16x16x32_bf16 a[28:31], v[28:31], v[56:59], a[28:31]
    s_waitcnt lgkmcnt(1)
    v_mfma_f32_16x16x32_bf16 a[24:27], v[20:23], v[60:63], a[24:27]
    v_mfma_f32_16x16x32_bf16 a[28:31], v[24:27], v[60:63], a[28:31]
    s_waitcnt lgkmcnt(0)
    v_mfma_f32_16x16x32_bf16 a[28:31], v[20:23], v[64:67], a[28:31]
    ds_write_b128 v3, a[0:3] offset:0
    ds_write_b128 v3, a[4:7] offset:1280
    ds_write_b128 v3, a[8:11] offset:2560
    ds_write_b128 v3, a[12:15] offset:3840
    s_waitcnt lgkmcnt(0)
    ds_read_b128 v[36:39], v2 offset:448
    ds_read_b128 v[40:43], v2 offset:960
    ds_read_b128 v[44:47], v2 offset:1472
    ds_read_b128 v[48:51], v2 offset:1984
    s_barrier
    ds_read_b64 v[4:5], v1 offset:1728
    ds_read_b64 v[6:7], v1 offset:1736
    ds_read_b64 v[8:9], v1 offset:1216
    ds_read_b64 v[10:11], v1 offset:1224
    ds_read_b64 v[12:13], v1 offset:704
    ds_read_b64 v[14:15], v1 offset:712
    ds_read_b64 v[16:17], v1 offset:192
    ds_read_b64 v[18:19], v1 offset:200
    s_waitcnt lgkmcnt(6)
    v_mfma_f32_16x16x32_bf16 a[16:19], v[4:7], v[36:39], a[16:19]
    ds_read_b64 v[20:21], v1 offset:1664
    s_waitcnt lgkmcnt(5)
    v_mfma_f32_16x16x32_bf16 a[20:23], v[8:11], v[36:39], a[20:23]
    ds_read_b64 v[22:23], v1 offset:1672
    s_waitcnt lgkmcnt(4)
    v_mfma_f32_16x16x32_bf16 a[24:27], v[12:15], v[36:39], a[24:27]
    ds_read_b64 v[24:25], v1 offset:1152
    s_waitcnt lgkmcnt(3)
    v_mfma_f32_16x16x32_bf16 a[28:31], v[16:19], v[36:39], a[28:31]
    ds_read_b64 v[26:27], v1 offset:1160
    ds_read_b128 v[36:39], v2 offset:384
    v_mfma_f32_16x16x32_bf16 a[20:23], v[4:7], v[40:43], a[20:23]
    ds_read_b64 v[28:29], v1 offset:640
    v_mfma_f32_16x16x32_bf16 a[24:27], v[8:11], v[40:43], a[24:27]
    ds_read_b64 v[30:31], v1 offset:648
    v_mfma_f32_16x16x32_bf16 a[28:31], v[12:15], v[40:43], a[28:31]
    ds_read_b64 v[32:33], v1 offset:128
    ds_read_b128 v[40:43], v2 offset:896
    v_mfma_f32_16x16x32_bf16 a[24:27], v[4:7], v[44:47], a[24:27]
    ds_read_b64 v[34:35], v1 offset:136
    v_mfma_f32_16x16x32_bf16 a[28:31], v[8:11], v[44:47], a[28:31]
    ds_read_b128 v[44:47], v2 offset:1408
    v_mfma_f32_16x16x32_bf16 a[28:31], v[4:7], v[48:51], a[28:31]
    ds_read_b128 v[48:51], v2 offset:1920
    s_waitcnt lgkmcnt(7)
    v_mfma_f32_16x16x32_bf16 a[16:19], v[20:23], v[36:39], a[16:19]
    ds_read_b64 v[4:5], v1 offset:1600
    v_mfma_f32_16x16x32_bf16 a[20:23], v[24:27], v[36:39], a[20:23]
    ds_read_b64 v[6:7], v1 offset:1608
    s_waitcnt lgkmcnt(7)
    v_mfma_f32_16x16x32_bf16 a[24:27], v[28:31], v[36:39], a[24:27]
    ds_read_b64 v[8:9], v1 offset:1088
    s_waitcnt lgkmcnt(5)
    v_mfma_f32_16x16x32_bf16 a[28:31], v[32:35], v[36:39], a[28:31]
    ds_read_b64 v[10:11], v1 offset:1096
    ds_read_b128 v[36:39], v2 offset:320
    v_mfma_f32_16x16x32_bf16 a[20:23], v[20:23], v[40:43], a[20:23]
    ds_read_b64 v[12:13], v1 offset:576
    v_mfma_f32_16x16x32_bf16 a[24:27], v[24:27], v[40:43], a[24:27]
    ds_read_b64 v[14:15], v1 offset:584
    v_mfma_f32_16x16x32_bf16 a[28:31], v[28:31], v[40:43], a[28:31]
    ds_read_b64 v[16:17], v1 offset:64
    ds_read_b128 v[40:43], v2 offset:832
    s_waitcnt lgkmcnt(10)
    v_mfma_f32_16x16x32_bf16 a[24:27], v[20:23], v[44:47], a[24:27]
    ds_read_b64 v[18:19], v1 offset:72
    v_mfma_f32_16x16x32_bf16 a[28:31], v[24:27], v[44:47], a[28:31]
    ds_read_b128 v[44:47], v2 offset:1344
    s_waitcnt lgkmcnt(11)
    v_mfma_f32_16x16x32_bf16 a[28:31], v[20:23], v[48:51], a[28:31]
    ds_read_b128 v[48:51], v2 offset:1856
    s_waitcnt lgkmcnt(7)
    v_mfma_f32_16x16x32_bf16 a[16:19], v[4:7], v[36:39], a[16:19]
    ds_read_b64 v[20:21], v1 offset:1536
    v_mfma_f32_16x16x32_bf16 a[20:23], v[8:11], v[36:39], a[20:23]
    ds_read_b64 v[22:23], v1 offset:1544
    s_waitcnt lgkmcnt(7)
    v_mfma_f32_16x16x32_bf16 a[24:27], v[12:15], v[36:39], a[24:27]
    ds_read_b64 v[24:25], v1 offset:1024
    s_waitcnt lgkmcnt(5)
    v_mfma_f32_16x16x32_bf16 a[28:31], v[16:19], v[36:39], a[28:31]
    ds_read_b64 v[26:27], v1 offset:1032
    ds_read_b128 v[36:39], v2 offset:256
    v_mfma_f32_16x16x32_bf16 a[20:23], v[4:7], v[40:43], a[20:23]
    ds_read_b64 v[28:29], v1 offset:512
    v_mfma_f32_16x16x32_bf16 a[24:27], v[8:11], v[40:43], a[24:27]
    ds_read_b64 v[30:31], v1 offset:520
    v_mfma_f32_16x16x32_bf16 a[28:31], v[12:15], v[40:43], a[28:31]
    ds_read_b64 v[32:33], v1 offset:0
    ds_read_b128 v[40:43], v2 offset:768
    s_waitcnt lgkmcnt(10)
    v_mfma_f32_16x16x32_bf16 a[24:27], v[4:7], v[44:47], a[24:27]
    ds_read_b64 v[34:35], v1 offset:8
    v_mfma_f32_16x16x32_bf16 a[28:31], v[8:11], v[44:47], a[28:31]
    ds_read_b128 v[44:47], v2 offset:1280
    s_waitcnt lgkmcnt(11)
    v_mfma_f32_16x16x32_bf16 a[28:31], v[4:7], v[48:51], a[28:31]
    ds_read_b128 v[48:51], v2 offset:1792
    s_waitcnt lgkmcnt(7)
    v_mfma_f32_16x16x32_bf16 a[16:19], v[20:23], v[36:39], a[16:19]
    v_mfma_f32_16x16x32_bf16 a[20:23], v[24:27], v[36:39], a[20:23]
    s_waitcnt lgkmcnt(5)
    v_mfma_f32_16x16x32_bf16 a[24:27], v[28:31], v[36:39], a[24:27]
    s_waitcnt lgkmcnt(2)
    v_mfma_f32_16x16x32_bf16 a[28:31], v[32:35], v[36:39], a[28:31]
    v_mfma_f32_16x16x32_bf16 a[20:23], v[20:23], v[40:43], a[20:23]
    v_mfma_f32_16x16x32_bf16 a[24:27], v[24:27], v[40:43], a[24:27]
    v_mfma_f32_16x16x32_bf16 a[28:31], v[28:31], v[40:43], a[28:31]
    s_waitcnt lgkmcnt(1)
    v_mfma_f32_16x16x32_bf16 a[24:27], v[20:23], v[44:47], a[24:27]
    v_mfma_f32_16x16x32_bf16 a[28:31], v[24:27], v[44:47], a[28:31]
    s_waitcnt lgkmcnt(0)
    v_mfma_f32_16x16x32_bf16 a[28:31], v[20:23], v[48:51], a[28:31]
    s_barrier
    ds_write_b128 v3, a[16:19] offset:0
    ds_write_b128 v3, a[20:23] offset:1280
    s_nop 1
    ds_write_b128 v3, a[24:27] offset:2560
    s_nop 1
    ds_write_b128 v3, a[28:31] offset:3840
    s_waitcnt lgkmcnt(0)
    s_waitcnt vmcnt(0)
    s_barrier
    s_load_dwordx2 s[4:5], s[0:1], 0
    s_load_dwordx4 s[12:15], s[0:1], 112
    v_bfe_u32 v69, v0, 3, 2
    v_lshlrev_b32 v69, 3, v69
    v_lshrrev_b32 v68, 6, v0
    v_lshl_add_u32 v68, v68, 5, v69
    v_and_b32 v4, 0x27, v0
    v_cmp_eq_u32 s[18:19], 0, v4
    s_lshl_b32 s56, s3, 6
    v_add_u32 v70, s56, v69
    s_mov_b32 s17, 8320
    v_mul_lo_u32 v71, v0, s17
    s_lshl_b32 s56, s3, 4
    v_add_u32 v71, s56, v71
    v_lshlrev_b32 v72, 3, v0
    v_and_b32 v73, 0xe0, v0
    s_lshl_b32 s56, s3, 12
    v_lshlrev_b32 v74, 2, v0
    v_add_u32 v74, s56, v74
    v_lshlrev_b32 v75, 4, v0
    v_add_u32 v75, 63488, v75
    s_mov_b32 s52, 0x3b000000
    s_mov_b32 s53, 0x3727c5ac
    s_mov_b32 s54, 0x3c000000
    s_mov_b32 s55, 0x43000000
    s_mov_b32 s57, 0
    s_mov_b32 s58, 0x100000
    s_movk_i32 s61, 0x1000
    s_mov_b32 s97, 0
    s_waitcnt lgkmcnt(0)
    s_mov_b32 s6, 0x200000
    s_mov_b32 s7, 0x20000
    s_mov_b32 s8, s12
    s_mov_b32 s9, s13
    s_mov_b32 s10, 0x100
    s_mov_b32 s11, 0x20000
    s_add_u32 s20, s14, 0xc00000
    s_addc_u32 s21, s15, 0
    s_mov_b32 s22, 0x208000
    s_mov_b32 s23, 0x20000
    s_add_u32 s24, s14, 0x800000
    s_addc_u32 s25, s15, 0
    s_mov_b32 s26, 0x208000
    s_mov_b32 s27, 0x20000
    s_add_u32 s28, s14, 0x1400000
    s_addc_u32 s29, s15, 0
    s_mov_b32 s30, 0x10000
    s_mov_b32 s31, 0x20000
    s_add_u32 s40, s14, 0x1430000
    s_addc_u32 s41, s15, 0
    s_mov_b32 s42, 0x2000
    s_mov_b32 s43, 0x20000
    v_and_b32 v4, 0xe7, v0
    v_cmp_eq_u32 s[14:15], 0, v4
    s_mov_b32 s89, 0
PM_tag:
    buffer_load_dwordx2 v[76:77], v73, s[8:11], 0 offen sc1
    s_waitcnt vmcnt(0)
    v_cmp_eq_u32 vcc, 0, v76
    s_add_u32 s89, s89, 1
    s_cbranch_vccz PM_tagd
    s_sleep 8
    s_cmp_lt_u32 s89, 1048576
    s_cbranch_scc1 PM_tag
PM_tagd:
    s_mov_b32 s89, 0
PM_fa:
    buffer_load_dwordx2 v[60:61], v72, s[40:43], 0 offen sc1
    s_waitcnt vmcnt(0)
    v_cmp_ne_u64 vcc, v[76:77], v[60:61]
    s_add_u32 s89, s89, 1
    s_cbranch_vccz PM_fad
    s_sleep 8
    s_cmp_lt_u32 s89, 1048576
    s_cbranch_scc1 PM_fa
PM_fad:
PM_loop:
    s_cmp_eq_u32 s97, 0
    s_cbranch_scc0 PMh0_e1
    buffer_load_dwordx4 v[8:11], v71, s[24:27], 0 offen sc1
    buffer_load_dword v4, v74, s[4:7], 0 offen offset:0
    buffer_load_dword v5, v74, s[4:7], 0 offen offset:1024
    buffer_load_dword v6, v74, s[4:7], 0 offen offset:2048
    buffer_load_dword v7, v74, s[4:7], 0 offen offset:3072
    buffer_load_dword v52, v74, s[4:7], s58 offen offset:0
    buffer_load_dword v53, v74, s[4:7], s58 offen offset:1024
    buffer_load_dword v54, v74, s[4:7], s58 offen offset:2048
    buffer_load_dword v55, v74, s[4:7], s58 offen offset:3072
    s_waitcnt vmcnt(4)
    s_branch PMh0_e2
PMh0_e1:
    ds_read_b128 v[8:11], v75
    ds_read_b128 v[56:59], v75 offset:4096
    s_waitcnt lgkmcnt(0)
    s_mov_b32 s89, 0
PMh0x_chk:
    s_waitcnt vmcnt(0)
    v_max3_u32 v46, v88, v89, v90
    v_max_u32 v46, v46, v91
    v_cmp_eq_u32 vcc, -1, v46
    s_add_u32 s89, s89, 1
    s_cbranch_vccz PMh0x_ok
    s_cmp_ge_u32 s89, 1048576
    s_cbranch_scc1 PMh0x_ok
    s_sleep 4
    buffer_load_dwordx4 v[88:91], v71, s[20:23], 0 offen sc1
    s_branch PMh0x_chk
PMh0x_ok:
    v_mov_b32 v4, v88
    v_mov_b32 v5, v89
    v_mov_b32 v6, v90
    v_mov_b32 v7, v91
PMh0_e2:
    v_lshlrev_b32 v12, 16, v4
    v_and_b32 v13, 0xffff0000, v4
    v_lshlrev_b32 v14, 16, v5
    v_and_b32 v15, 0xffff0000, v5
    v_lshlrev_b32 v16, 16, v6
    v_and_b32 v17, 0xffff0000, v6
    v_lshlrev_b32 v18, 16, v7
    v_and_b32 v19, 0xffff0000, v7
    v_readfirstlane_b32 s44, v12
    v_readfirstlane_b32 s46, v14
    v_readfirstlane_b32 s48, v16
    v_readfirstlane_b32 s50, v18
    v_add_f32 v20, v12, v13
    v_add_f32 v21, v14, v15
    v_add_f32 v22, v16, v17
    v_add_f32 v23, v18, v19
    v_pk_add_f32 v[28:29], v[12:13], s[44:45] op_sel_hi:[1,0] neg_lo:[0,1] neg_hi:[0,1]
    v_pk_add_f32 v[30:31], v[14:15], s[46:47] op_sel_hi:[1,0] neg_lo:[0,1] neg_hi:[0,1]
    v_pk_add_f32 v[32:33], v[16:17], s[48:49] op_sel_hi:[1,0] neg_lo:[0,1] neg_hi:[0,1]
    v_pk_add_f32 v[34:35], v[18:19], s[50:51] op_sel_hi:[1,0] neg_lo:[0,1] neg_hi:[0,1]
    v_writelane_b32 v38, s44, 0
    v_writelane_b32 v38, s46, 8
    v_writelane_b32 v38, s48, 16
    v_writelane_b32 v38, s50, 24
    v_mul_f32 v24, v28, v28
    v_mul_f32 v25, v30, v30
    v_mul_f32 v26, v32, v32
    v_mul_f32 v27, v34, v34
    v_fmac_f32 v24, v29, v29
    v_fmac_f32 v25, v31, v31
    v_fmac_f32 v26, v33, v33
    v_fmac_f32 v27, v35, v35
    v_permlane32_swap_b32 v20, v24
    v_permlane32_swap_b32 v21, v25
    v_permlane32_swap_b32 v22, v26
    v_permlane32_swap_b32 v23, v27
    v_add_f32 v20, v20, v24
    v_add_f32 v21, v21, v25
    v_add_f32 v22, v22, v26
    v_add_f32 v23, v23, v27
    s_nop 0
    v_permlane16_swap_b32 v20, v22
    v_permlane16_swap_b32 v21, v23
    v_add_f32 v20, v20, v22
    v_add_f32 v21, v21, v23
    s_nop 0
    v_add_f32_dpp v36, v20, v20 row_ror:8 row_mask:0xf bank_mask:0x3
    s_nop 1
    v_add_f32_dpp v36, v21, v21 row_ror:8 row_mask:0xf bank_mask:0xc
    s_nop 1
    v_add_f32_dpp v36, v36, v36 row_half_mirror row_mask:0xf bank_mask:0xf
    s_nop 1
    v_add_f32_dpp v36, v36, v36 quad_perm:[1,0,3,2] row_mask:0xf bank_mask:0xf
    s_nop 1
    v_add_f32_dpp v36, v36, v36 quad_perm:[2,3,0,1] row_mask:0xf bank_mask:0xf
    v_mov_b32 v37, v36
    s_nop 1
    v_permlane32_swap_b32 v36, v37
    v_fma_f32 v38, -v38, s55, v36
    v_mul_f32 v39, s54, v38
    v_fma_f32 v37, -v39, v38, v37
    s_mov_b64 exec, s[18:19]
    ds_write_b64 v68, v[36:37] offset:42560
    s_mov_b64 exec, -1
    s_add_u32 s57, s57, 4
    v_mov_b32 v40, 0
    v_mov_b32 v41, 1
    s_waitcnt lgkmcnt(0)
    s_mov_b64 exec, 1
    ds_add_u32 v40, v41 offset:42528
    s_mov_b64 exec, -1
    v_mov_b32 v40, 0
LW_1:
    ds_read_b32 v41, v40 offset:42528
    s_waitcnt lgkmcnt(0)
    v_readfirstlane_b32 s88, v41
    s_cmp_ge_u32 s88, s57
    s_cbranch_scc1 LW_1_d
    s_sleep 1
    s_branch LW_1
LW_1_d:
    ds_read_b64 v[40:41], v69 offset:42560
    ds_read_b64 v[42:43], v69 offset:42592
    ds_read_b64 v[44:45], v69 offset:42624
    ds_read_b64 v[46:47], v69 offset:42656
    s_waitcnt lgkmcnt(0)
    v_pk_add_f32 v[36:37], v[40:41], v[42:43]
    v_pk_add_f32 v[38:39], v[44:45], v[46:47]
    v_pk_add_f32 v[36:37], v[36:37], v[38:39]
    v_mul_f32 v36, s52, v36
    v_fma_f32 v40, v40, s54, -v36
    v_fma_f32 v42, v42, s54, -v36
    v_fma_f32 v44, v44, s54, -v36
    v_fma_f32 v46, v46, s54, -v36
    v_mul_f32 v38, v40, v40
    v_fmac_f32 v38, v42, v42
    v_fmac_f32 v38, v44, v44
    v_fmac_f32 v38, v46, v46
    v_fma_f32 v37, v38, s55, v37
    v_mul_f32 v37, s52, v37
    v_cvt_pk_bf16_f32 v38, v36, v37
    v_lshlrev_b32 v36, 16, v38
    v_and_b32 v37, 0xffff0000, v38
    v_mov_b32 v48, v36
    v_add_f32 v37, s53, v37
    v_cvt_pk_bf16_f32 v37, v37, v37
    v_lshlrev_b32 v37, 16, v37
    v_sqrt_f32 v37, v37
    s_nop 0
    v_cvt_pk_bf16_f32 v37, v37, v37
    v_lshlrev_b32 v37, 16, v37
    v_cvt_pk_bf16_f32 v50, v48, v37
    v_rcp_f32 v49, v37
    v_readlane_b32 s44, v48, 0
    v_readlane_b32 s32, v49, 0
    v_readlane_b32 s46, v48, 8
    v_readlane_b32 s34, v49, 8
    v_readlane_b32 s48, v48, 16
    v_readlane_b32 s36, v49, 16
    v_readlane_b32 s50, v48, 24
    v_readlane_b32 s38, v49, 24
    s_cmp_eq_u32 s97, 0
    s_cbranch_scc0 PMh0_m1
    s_mov_b32 s89, 0
PMh0y_chk:
    s_waitcnt vmcnt(0)
    v_max3_u32 v46, v8, v9, v10
    v_max_u32 v46, v46, v11
    v_cmp_eq_u32 vcc, -1, v46
    s_add_u32 s89, s89, 1
    s_cbranch_vccz PMh0y_ok
    s_cmp_ge_u32 s89, 1048576
    s_cbranch_scc1 PMh0y_ok
    s_sleep 4
    buffer_load_dwordx4 v[8:11], v71, s[24:27], 0 offen sc1
    s_branch PMh0y_chk
PMh0y_ok:
    s_branch PMh0_m2
PMh0_m1:
PMh0_m2:
    s_cmp_eq_u32 s97, 0
    s_cbranch_scc0 PMh0_n1
    buffer_load_dwordx4 v[56:59], v71, s[24:27], s61 offen sc1
    s_branch PMh0_n2
PMh0_n1:
    buffer_load_dwordx4 v[52:55], v71, s[20:23], s61 offen sc1
PMh0_n2:
    ds_write_b128 v75, v[8:11] offset:0
    v_pk_add_f32 v[28:29], v[12:13], s[44:45] op_sel_hi:[1,0] neg_lo:[0,1] neg_hi:[0,1]
    v_pk_add_f32 v[30:31], v[14:15], s[46:47] op_sel_hi:[1,0] neg_lo:[0,1] neg_hi:[0,1]
    v_pk_add_f32 v[32:33], v[16:17], s[48:49] op_sel_hi:[1,0] neg_lo:[0,1] neg_hi:[0,1]
    v_pk_add_f32 v[34:35], v[18:19], s[50:51] op_sel_hi:[1,0] neg_lo:[0,1] neg_hi:[0,1]
    v_cvt_pk_bf16_f32 v36, v28, v29
    v_cvt_pk_bf16_f32 v37, v30, v31
    v_cvt_pk_bf16_f32 v38, v32, v33
    v_cvt_pk_bf16_f32 v39, v34, v35
    v_lshlrev_b32 v28, 16, v36
    v_lshlrev_b32 v30, 16, v37
    v_lshlrev_b32 v32, 16, v38
    v_lshlrev_b32 v34, 16, v39
    v_and_b32 v29, 0xffff0000, v36
    v_and_b32 v31, 0xffff0000, v37
    v_and_b32 v33, 0xffff0000, v38
    v_and_b32 v35, 0xffff0000, v39
    v_pk_mul_f32 v[28:29], v[28:29], s[32:33] op_sel_hi:[1,0]
    v_pk_mul_f32 v[30:31], v[30:31], s[34:35] op_sel_hi:[1,0]
    v_pk_mul_f32 v[32:33], v[32:33], s[36:37] op_sel_hi:[1,0]
    v_pk_mul_f32 v[34:35], v[34:35], s[38:39] op_sel_hi:[1,0]
    v_cvt_pk_bf16_f32 v36, v28, v29
    v_cvt_pk_bf16_f32 v37, v30, v31
    v_cvt_pk_bf16_f32 v38, v32, v33
    v_cvt_pk_bf16_f32 v39, v34, v35
    v_lshlrev_b32 v28, 16, v36
    v_lshlrev_b32 v30, 16, v37
    v_lshlrev_b32 v32, 16, v38
    v_lshlrev_b32 v34, 16, v39
    v_and_b32 v29, 0xffff0000, v36
    v_and_b32 v31, 0xffff0000, v37
    v_and_b32 v33, 0xffff0000, v38
    v_and_b32 v35, 0xffff0000, v39
    v_lshlrev_b32 v20, 16, v8
    v_lshlrev_b32 v22, 16, v9
    v_lshlrev_b32 v24, 16, v10
    v_lshlrev_b32 v26, 16, v11
    v_and_b32 v21, 0xffff0000, v8
    v_and_b32 v23, 0xffff0000, v9
    v_and_b32 v25, 0xffff0000, v10
    v_and_b32 v27, 0xffff0000, v11
    v_pk_mul_f32 v[28:29], v[28:29], v[20:21]
    v_pk_mul_f32 v[30:31], v[30:31], v[22:23]
    v_pk_mul_f32 v[32:33], v[32:33], v[24:25]
    v_pk_mul_f32 v[34:35], v[34:35], v[26:27]
    v_cvt_pk_bf16_f32 v36, v28, v29
    v_cvt_pk_bf16_f32 v37, v30, v31
    v_cvt_pk_bf16_f32 v38, v32, v33
    v_cvt_pk_bf16_f32 v39, v34, v35
    v_lshlrev_b32 v28, 16, v36
    v_lshlrev_b32 v30, 16, v37
    v_lshlrev_b32 v32, 16, v38
    v_lshlrev_b32 v34, 16, v39
    v_and_b32 v29, 0xffff0000, v36
    v_and_b32 v31, 0xffff0000, v37
    v_and_b32 v33, 0xffff0000, v38
    v_and_b32 v35, 0xffff0000, v39
    v_pk_add_f32 v[12:13], v[12:13], v[28:29]
    v_pk_add_f32 v[14:15], v[14:15], v[30:31]
    v_pk_add_f32 v[16:17], v[16:17], v[32:33]
    v_pk_add_f32 v[18:19], v[18:19], v[34:35]
    v_cvt_pk_bf16_f32 v36, v12, v13
    v_cvt_pk_bf16_f32 v37, v14, v15
    v_cvt_pk_bf16_f32 v38, v16, v17
    v_cvt_pk_bf16_f32 v39, v18, v19
    v_lshlrev_b32 v12, 16, v36
    v_lshlrev_b32 v14, 16, v37
    v_lshlrev_b32 v16, 16, v38
    v_lshlrev_b32 v18, 16, v39
    v_and_b32 v13, 0xffff0000, v36
    v_and_b32 v15, 0xffff0000, v37
    v_and_b32 v17, 0xffff0000, v38
    v_and_b32 v19, 0xffff0000, v39
    v_readfirstlane_b32 s44, v12
    v_readfirstlane_b32 s46, v14
    v_readfirstlane_b32 s48, v16
    v_readfirstlane_b32 s50, v18
    v_add_f32 v20, v12, v13
    v_add_f32 v21, v14, v15
    v_add_f32 v22, v16, v17
    v_add_f32 v23, v18, v19
    v_pk_add_f32 v[28:29], v[12:13], s[44:45] op_sel_hi:[1,0] neg_lo:[0,1] neg_hi:[0,1]
    v_pk_add_f32 v[30:31], v[14:15], s[46:47] op_sel_hi:[1,0] neg_lo:[0,1] neg_hi:[0,1]
    v_pk_add_f32 v[32:33], v[16:17], s[48:49] op_sel_hi:[1,0] neg_lo:[0,1] neg_hi:[0,1]
    v_pk_add_f32 v[34:35], v[18:19], s[50:51] op_sel_hi:[1,0] neg_lo:[0,1] neg_hi:[0,1]
    v_writelane_b32 v38, s44, 0
    v_writelane_b32 v38, s46, 8
    v_writelane_b32 v38, s48, 16
    v_writelane_b32 v38, s50, 24
    v_mul_f32 v24, v28, v28
    v_mul_f32 v25, v30, v30
    v_mul_f32 v26, v32, v32
    v_mul_f32 v27, v34, v34
    v_fmac_f32 v24, v29, v29
    v_fmac_f32 v25, v31, v31
    v_fmac_f32 v26, v33, v33
    v_fmac_f32 v27, v35, v35
    v_permlane32_swap_b32 v20, v24
    v_permlane32_swap_b32 v21, v25
    v_permlane32_swap_b32 v22, v26
    v_permlane32_swap_b32 v23, v27
    v_add_f32 v20, v20, v24
    v_add_f32 v21, v21, v25
    v_add_f32 v22, v22, v26
    v_add_f32 v23, v23, v27
    s_nop 0
    v_permlane16_swap_b32 v20, v22
    v_permlane16_swap_b32 v21, v23
    v_add_f32 v20, v20, v22
    v_add_f32 v21, v21, v23
    s_nop 0
    v_add_f32_dpp v36, v20, v20 row_ror:8 row_mask:0xf bank_mask:0x3
    s_nop 1
    v_add_f32_dpp v36, v21, v21 row_ror:8 row_mask:0xf bank_mask:0xc
    s_nop 1
    v_add_f32_dpp v36, v36, v36 row_half_mirror row_mask:0xf bank_mask:0xf
    s_nop 1
    v_add_f32_dpp v36, v36, v36 quad_perm:[1,0,3,2] row_mask:0xf bank_mask:0xf
    s_nop 1
    v_add_f32_dpp v36, v36, v36 quad_perm:[2,3,0,1] row_mask:0xf bank_mask:0xf
    v_mov_b32 v37, v36
    s_nop 1
    v_permlane32_swap_b32 v36, v37
    v_fma_f32 v38, -v38, s55, v36
    v_mul_f32 v39, s54, v38
    v_fma_f32 v37, -v39, v38, v37
    s_mov_b64 exec, s[18:19]
    ds_write_b64 v68, v[36:37] offset:42688
    s_mov_b64 exec, -1
    s_add_u32 s57, s57, 4
    v_mov_b32 v40, 0
    v_mov_b32 v41, 1
    s_waitcnt lgkmcnt(0)
    s_mov_b64 exec, 1
    ds_add_u32 v40, v41 offset:42528
    s_mov_b64 exec, -1
    v_mov_b32 v40, 0
LW_2:
    ds_read_b32 v41, v40 offset:42528
    s_waitcnt lgkmcnt(0)
    v_readfirstlane_b32 s88, v41
    s_cmp_ge_u32 s88, s57
    s_cbranch_scc1 LW_2_d
    s_sleep 1
    s_branch LW_2
LW_2_d:
    ds_read_b64 v[40:41], v69 offset:42688
    ds_read_b64 v[42:43], v69 offset:42720
    ds_read_b64 v[44:45], v69 offset:42752
    ds_read_b64 v[46:47], v69 offset:42784
    s_waitcnt lgkmcnt(0)
    v_pk_add_f32 v[36:37], v[40:41], v[42:43]
    v_pk_add_f32 v[38:39], v[44:45], v[46:47]
    v_pk_add_f32 v[36:37], v[36:37], v[38:39]
    v_mul_f32 v36, s52, v36
    v_fma_f32 v40, v40, s54, -v36
    v_fma_f32 v42, v42, s54, -v36
    v_fma_f32 v44, v44, s54, -v36
    v_fma_f32 v46, v46, s54, -v36
    v_mul_f32 v38, v40, v40
    v_fmac_f32 v38, v42, v42
    v_fmac_f32 v38, v44, v44
    v_fmac_f32 v38, v46, v46
    v_fma_f32 v37, v38, s55, v37
    v_mul_f32 v37, s52, v37
    v_cvt_pk_bf16_f32 v38, v36, v37
    v_lshlrev_b32 v36, 16, v38
    v_and_b32 v37, 0xffff0000, v38
    v_mov_b32 v48, v36
    v_add_f32 v37, s53, v37
    v_cvt_pk_bf16_f32 v37, v37, v37
    v_lshlrev_b32 v37, 16, v37
    v_sqrt_f32 v37, v37
    s_nop 0
    v_cvt_pk_bf16_f32 v37, v37, v37
    v_lshlrev_b32 v37, 16, v37
    v_cvt_pk_bf16_f32 v51, v48, v37
    v_min_u32 v50, 0xfffffffe, v50
    v_min_u32 v51, 0xfffffffe, v51
    s_lshl_b32 s59, s97, 15
    s_add_u32 s59, s59, 0
    s_and_saveexec_b64 s[16:17], s[14:15]
    s_cbranch_execz PMh0_nopub
    buffer_store_dwordx2 v[50:51], v70, s[28:31], s59 offen sc1
    s_mov_b64 exec, -1
    v_mov_b32 v40, 0
    v_mov_b32 v41, 1
    s_waitcnt lgkmcnt(0)
    s_mov_b64 exec, 1
    ds_add_u32 v40, v41 offset:42532
    s_mov_b64 exec, -1
PMh0_nopub:
    s_mov_b64 exec, -1
    s_cmp_eq_u32 s97, 0
    s_cbranch_scc0 PMh1_e1
    s_branch PMh1_e2
PMh1_e1:
    s_mov_b32 s89, 0
PMh1x_chk:
    s_waitcnt vmcnt(0)
    v_max3_u32 v46, v52, v53, v54
    v_max_u32 v46, v46, v55
    v_cmp_eq_u32 vcc, -1, v46
    s_add_u32 s89, s89, 1
    s_cbranch_vccz PMh1x_ok
    s_cmp_ge_u32 s89, 1048576
    s_cbranch_scc1 PMh1x_ok
    s_sleep 4
    buffer_load_dwordx4 v[52:55], v71, s[20:23], s61 offen sc1
    s_branch PMh1x_chk
PMh1x_ok:
PMh1_e2:
    v_lshlrev_b32 v12, 16, v52
    v_and_b32 v13, 0xffff0000, v52
    v_lshlrev_b32 v14, 16, v53
    v_and_b32 v15, 0xffff0000, v53
    v_lshlrev_b32 v16, 16, v54
    v_and_b32 v17, 0xffff0000, v54
    v_lshlrev_b32 v18, 16, v55
    v_and_b32 v19, 0xffff0000, v55
    v_readfirstlane_b32 s44, v12
    v_readfirstlane_b32 s46, v14
    v_readfirstlane_b32 s48, v16
    v_readfirstlane_b32 s50, v18
    v_add_f32 v20, v12, v13
    v_add_f32 v21, v14, v15
    v_add_f32 v22, v16, v17
    v_add_f32 v23, v18, v19
    v_pk_add_f32 v[28:29], v[12:13], s[44:45] op_sel_hi:[1,0] neg_lo:[0,1] neg_hi:[0,1]
    v_pk_add_f32 v[30:31], v[14:15], s[46:47] op_sel_hi:[1,0] neg_lo:[0,1] neg_hi:[0,1]
    v_pk_add_f32 v[32:33], v[16:17], s[48:49] op_sel_hi:[1,0] neg_lo:[0,1] neg_hi:[0,1]
    v_pk_add_f32 v[34:35], v[18:19], s[50:51] op_sel_hi:[1,0] neg_lo:[0,1] neg_hi:[0,1]
    v_writelane_b32 v38, s44, 0
    v_writelane_b32 v38, s46, 8
    v_writelane_b32 v38, s48, 16
    v_writelane_b32 v38, s50, 24
    v_mul_f32 v24, v28, v28
    v_mul_f32 v25, v30, v30
    v_mul_f32 v26, v32, v32
    v_mul_f32 v27, v34, v34
    v_fmac_f32 v24, v29, v29
    v_fmac_f32 v25, v31, v31
    v_fmac_f32 v26, v33, v33
    v_fmac_f32 v27, v35, v35
    v_permlane32_swap_b32 v20, v24
    v_permlane32_swap_b32 v21, v25
    v_permlane32_swap_b32 v22, v26
    v_permlane32_swap_b32 v23, v27
    v_add_f32 v20, v20, v24
    v_add_f32 v21, v21, v25
    v_add_f32 v22, v22, v26
    v_add_f32 v23, v23, v27
    s_nop 0
    v_permlane16_swap_b32 v20, v22
    v_permlane16_swap_b32 v21, v23
    v_add_f32 v20, v20, v22
    v_add_f32 v21, v21, v23
    s_nop 0
    v_add_f32_dpp v36, v20, v20 row_ror:8 row_mask:0xf bank_mask:0x3
    s_nop 1
    v_add_f32_dpp v36, v21, v21 row_ror:8 row_mask:0xf bank_mask:0xc
    s_nop 1
    v_add_f32_dpp v36, v36, v36 row_half_mirror row_mask:0xf bank_mask:0xf
    s_nop 1
    v_add_f32_dpp v36, v36, v36 quad_perm:[1,0,3,2] row_mask:0xf bank_mask:0xf
    s_nop 1
    v_add_f32_dpp v36, v36, v36 quad_perm:[2,3,0,1] row_mask:0xf bank_mask:0xf
    v_mov_b32 v37, v36
    s_nop 1
    v_permlane32_swap_b32 v36, v37
    v_fma_f32 v38, -v38, s55, v36
    v_mul_f32 v39, s54, v38
    v_fma_f32 v37, -v39, v38, v37
    s_mov_b64 exec, s[18:19]
    ds_write_b64 v68, v[36:37] offset:42560
    s_mov_b64 exec, -1
    s_add_u32 s57, s57, 4
    v_mov_b32 v40, 0
    v_mov_b32 v41, 1
    s_waitcnt lgkmcnt(0)
    s_mov_b64 exec, 1
    ds_add_u32 v40, v41 offset:42528
    s_mov_b64 exec, -1
    v_mov_b32 v40, 0
LW_3:
    ds_read_b32 v41, v40 offset:42528
    s_waitcnt lgkmcnt(0)
    v_readfirstlane_b32 s88, v41
    s_cmp_ge_u32 s88, s57
    s_cbranch_scc1 LW_3_d
    s_sleep 1
    s_branch LW_3
LW_3_d:
    ds_read_b64 v[40:41], v69 offset:42560
    ds_read_b64 v[42:43], v69 offset:42592
    ds_read_b64 v[44:45], v69 offset:42624
    ds_read_b64 v[46:47], v69 offset:42656
    s_waitcnt lgkmcnt(0)
    v_pk_add_f32 v[36:37], v[40:41], v[42:43]
    v_pk_add_f32 v[38:39], v[44:45], v[46:47]
    v_pk_add_f32 v[36:37], v[36:37], v[38:39]
    v_mul_f32 v36, s52, v36
    v_fma_f32 v40, v40, s54, -v36
    v_fma_f32 v42, v42, s54, -v36
    v_fma_f32 v44, v44, s54, -v36
    v_fma_f32 v46, v46, s54, -v36
    v_mul_f32 v38, v40, v40
    v_fmac_f32 v38, v42, v42
    v_fmac_f32 v38, v44, v44
    v_fmac_f32 v38, v46, v46
    v_fma_f32 v37, v38, s55, v37
    v_mul_f32 v37, s52, v37
    v_cvt_pk_bf16_f32 v38, v36, v37
    v_lshlrev_b32 v36, 16, v38
    v_and_b32 v37, 0xffff0000, v38
    v_mov_b32 v48, v36
    v_add_f32 v37, s53, v37
    v_cvt_pk_bf16_f32 v37, v37, v37
    v_lshlrev_b32 v37, 16, v37
    v_sqrt_f32 v37, v37
    s_nop 0
    v_cvt_pk_bf16_f32 v37, v37, v37
    v_lshlrev_b32 v37, 16, v37
    v_cvt_pk_bf16_f32 v50, v48, v37
    v_rcp_f32 v49, v37
    v_readlane_b32 s44, v48, 0
    v_readlane_b32 s32, v49, 0
    v_readlane_b32 s46, v48, 8
    v_readlane_b32 s34, v49, 8
    v_readlane_b32 s48, v48, 16
    v_readlane_b32 s36, v49, 16
    v_readlane_b32 s50, v48, 24
    v_readlane_b32 s38, v49, 24
    s_cmp_eq_u32 s97, 0
    s_cbranch_scc0 PMh1_m1
    s_mov_b32 s89, 0
PMh1y_chk:
    s_waitcnt vmcnt(0)
    v_max3_u32 v46, v56, v57, v58
    v_max_u32 v46, v46, v59
    v_cmp_eq_u32 vcc, -1, v46
    s_add_u32 s89, s89, 1
    s_cbranch_vccz PMh1y_ok
    s_cmp_ge_u32 s89, 1048576
    s_cbranch_scc1 PMh1y_ok
    s_sleep 4
    buffer_load_dwordx4 v[56:59], v71, s[24:27], s61 offen sc1
    s_branch PMh1y_chk
PMh1y_ok:
    s_branch PMh1_m2
PMh1_m1:
PMh1_m2:
    ds_write_b128 v75, v[56:59] offset:4096
    v_pk_add_f32 v[28:29], v[12:13], s[44:45] op_sel_hi:[1,0] neg_lo:[0,1] neg_hi:[0,1]
    v_pk_add_f32 v[30:31], v[14:15], s[46:47] op_sel_hi:[1,0] neg_lo:[0,1] neg_hi:[0,1]
    v_pk_add_f32 v[32:33], v[16:17], s[48:49] op_sel_hi:[1,0] neg_lo:[0,1] neg_hi:[0,1]
    v_pk_add_f32 v[34:35], v[18:19], s[50:51] op_sel_hi:[1,0] neg_lo:[0,1] neg_hi:[0,1]
    v_cvt_pk_bf16_f32 v36, v28, v29
    v_cvt_pk_bf16_f32 v37, v30, v31
    v_cvt_pk_bf16_f32 v38, v32, v33
    v_cvt_pk_bf16_f32 v39, v34, v35
    v_lshlrev_b32 v28, 16, v36
    v_lshlrev_b32 v30, 16, v37
    v_lshlrev_b32 v32, 16, v38
    v_lshlrev_b32 v34, 16, v39
    v_and_b32 v29, 0xffff0000, v36
    v_and_b32 v31, 0xffff0000, v37
    v_and_b32 v33, 0xffff0000, v38
    v_and_b32 v35, 0xffff0000, v39
    v_pk_mul_f32 v[28:29], v[28:29], s[32:33] op_sel_hi:[1,0]
    v_pk_mul_f32 v[30:31], v[30:31], s[34:35] op_sel_hi:[1,0]
    v_pk_mul_f32 v[32:33], v[32:33], s[36:37] op_sel_hi:[1,0]
    v_pk_mul_f32 v[34:35], v[34:35], s[38:39] op_sel_hi:[1,0]
    v_cvt_pk_bf16_f32 v36, v28, v29
    v_cvt_pk_bf16_f32 v37, v30, v31
    v_cvt_pk_bf16_f32 v38, v32, v33
    v_cvt_pk_bf16_f32 v39, v34, v35
    v_lshlrev_b32 v28, 16, v36
    v_lshlrev_b32 v30, 16, v37
    v_lshlrev_b32 v32, 16, v38
    v_lshlrev_b32 v34, 16, v39
    v_and_b32 v29, 0xffff0000, v36
    v_and_b32 v31, 0xffff0000, v37
    v_and_b32 v33, 0xffff0000, v38
    v_and_b32 v35, 0xffff0000, v39
    v_lshlrev_b32 v20, 16, v56
    v_lshlrev_b32 v22, 16, v57
    v_lshlrev_b32 v24, 16, v58
    v_lshlrev_b32 v26, 16, v59
    v_and_b32 v21, 0xffff0000, v56
    v_and_b32 v23, 0xffff0000, v57
    v_and_b32 v25, 0xffff0000, v58
    v_and_b32 v27, 0xffff0000, v59
    v_pk_mul_f32 v[28:29], v[28:29], v[20:21]
    v_pk_mul_f32 v[30:31], v[30:31], v[22:23]
    v_pk_mul_f32 v[32:33], v[32:33], v[24:25]
    v_pk_mul_f32 v[34:35], v[34:35], v[26:27]
    v_cvt_pk_bf16_f32 v36, v28, v29
    v_cvt_pk_bf16_f32 v37, v30, v31
    v_cvt_pk_bf16_f32 v38, v32, v33
    v_cvt_pk_bf16_f32 v39, v34, v35
    v_lshlrev_b32 v28, 16, v36
    v_lshlrev_b32 v30, 16, v37
    v_lshlrev_b32 v32, 16, v38
    v_lshlrev_b32 v34, 16, v39
    v_and_b32 v29, 0xffff0000, v36
    v_and_b32 v31, 0xffff0000, v37
    v_and_b32 v33, 0xffff0000, v38
    v_and_b32 v35, 0xffff0000, v39
    v_pk_add_f32 v[12:13], v[12:13], v[28:29]
    v_pk_add_f32 v[14:15], v[14:15], v[30:31]
    v_pk_add_f32 v[16:17], v[16:17], v[32:33]
    v_pk_add_f32 v[18:19], v[18:19], v[34:35]
    v_cvt_pk_bf16_f32 v36, v12, v13
    v_cvt_pk_bf16_f32 v37, v14, v15
    v_cvt_pk_bf16_f32 v38, v16, v17
    v_cvt_pk_bf16_f32 v39, v18, v19
    v_lshlrev_b32 v12, 16, v36
    v_lshlrev_b32 v14, 16, v37
    v_lshlrev_b32 v16, 16, v38
    v_lshlrev_b32 v18, 16, v39
    v_and_b32 v13, 0xffff0000, v36
    v_and_b32 v15, 0xffff0000, v37
    v_and_b32 v17, 0xffff0000, v38
    v_and_b32 v19, 0xffff0000, v39
    v_readfirstlane_b32 s44, v12
    v_readfirstlane_b32 s46, v14
    v_readfirstlane_b32 s48, v16
    v_readfirstlane_b32 s50, v18
    v_add_f32 v20, v12, v13
    v_add_f32 v21, v14, v15
    v_add_f32 v22, v16, v17
    v_add_f32 v23, v18, v19
    v_pk_add_f32 v[28:29], v[12:13], s[44:45] op_sel_hi:[1,0] neg_lo:[0,1] neg_hi:[0,1]
    v_pk_add_f32 v[30:31], v[14:15], s[46:47] op_sel_hi:[1,0] neg_lo:[0,1] neg_hi:[0,1]
    v_pk_add_f32 v[32:33], v[16:17], s[48:49] op_sel_hi:[1,0] neg_lo:[0,1] neg_hi:[0,1]
    v_pk_add_f32 v[34:35], v[18:19], s[50:51] op_sel_hi:[1,0] neg_lo:[0,1] neg_hi:[0,1]
    v_writelane_b32 v38, s44, 0
    v_writelane_b32 v38, s46, 8
    v_writelane_b32 v38, s48, 16
    v_writelane_b32 v38, s50, 24
    v_mul_f32 v24, v28, v28
    v_mul_f32 v25, v30, v30
    v_mul_f32 v26, v32, v32
    v_mul_f32 v27, v34, v34
    v_fmac_f32 v24, v29, v29
    v_fmac_f32 v25, v31, v31
    v_fmac_f32 v26, v33, v33
    v_fmac_f32 v27, v35, v35
    v_permlane32_swap_b32 v20, v24
    v_permlane32_swap_b32 v21, v25
    v_permlane32_swap_b32 v22, v26
    v_permlane32_swap_b32 v23, v27
    v_add_f32 v20, v20, v24
    v_add_f32 v21, v21, v25
    v_add_f32 v22, v22, v26
    v_add_f32 v23, v23, v27
    s_nop 0
    v_permlane16_swap_b32 v20, v22
    v_permlane16_swap_b32 v21, v23
    v_add_f32 v20, v20, v22
    v_add_f32 v21, v21, v23
    s_nop 0
    v_add_f32_dpp v36, v20, v20 row_ror:8 row_mask:0xf bank_mask:0x3
    s_nop 1
    v_add_f32_dpp v36, v21, v21 row_ror:8 row_mask:0xf bank_mask:0xc
    s_nop 1
    v_add_f32_dpp v36, v36, v36 row_half_mirror row_mask:0xf bank_mask:0xf
    s_nop 1
    v_add_f32_dpp v36, v36, v36 quad_perm:[1,0,3,2] row_mask:0xf bank_mask:0xf
    s_nop 1
    v_add_f32_dpp v36, v36, v36 quad_perm:[2,3,0,1] row_mask:0xf bank_mask:0xf
    v_mov_b32 v37, v36
    s_nop 1
    v_permlane32_swap_b32 v36, v37
    v_fma_f32 v38, -v38, s55, v36
    v_mul_f32 v39, s54, v38
    v_fma_f32 v37, -v39, v38, v37
    s_mov_b64 exec, s[18:19]
    ds_write_b64 v68, v[36:37] offset:42688
    s_mov_b64 exec, -1
    s_add_u32 s57, s57, 4
    v_mov_b32 v40, 0
    v_mov_b32 v41, 1
    s_waitcnt lgkmcnt(0)
    s_mov_b64 exec, 1
    ds_add_u32 v40, v41 offset:42528
    s_mov_b64 exec, -1
    v_mov_b32 v40, 0
LW_4:
    ds_read_b32 v41, v40 offset:42528
    s_waitcnt lgkmcnt(0)
    v_readfirstlane_b32 s88, v41
    s_cmp_ge_u32 s88, s57
    s_cbranch_scc1 LW_4_d
    s_sleep 1
    s_branch LW_4
LW_4_d:
    ds_read_b64 v[40:41], v69 offset:42688
    ds_read_b64 v[42:43], v69 offset:42720
    ds_read_b64 v[44:45], v69 offset:42752
    ds_read_b64 v[46:47], v69 offset:42784
    s_waitcnt lgkmcnt(0)
    v_pk_add_f32 v[36:37], v[40:41], v[42:43]
    v_pk_add_f32 v[38:39], v[44:45], v[46:47]
    v_pk_add_f32 v[36:37], v[36:37], v[38:39]
    v_mul_f32 v36, s52, v36
    v_fma_f32 v40, v40, s54, -v36
    v_fma_f32 v42, v42, s54, -v36
    v_fma_f32 v44, v44, s54, -v36
    v_fma_f32 v46, v46, s54, -v36
    v_mul_f32 v38, v40, v40
    v_fmac_f32 v38, v42, v42
    v_fmac_f32 v38, v44, v44
    v_fmac_f32 v38, v46, v46
    v_fma_f32 v37, v38, s55, v37
    v_mul_f32 v37, s52, v37
    v_cvt_pk_bf16_f32 v38, v36, v37
    v_lshlrev_b32 v36, 16, v38
    v_and_b32 v37, 0xffff0000, v38
    v_mov_b32 v48, v36
    v_add_f32 v37, s53, v37
    v_cvt_pk_bf16_f32 v37, v37, v37
    v_lshlrev_b32 v37, 16, v37
    v_sqrt_f32 v37, v37
    s_nop 0
    v_cvt_pk_bf16_f32 v37, v37, v37
    v_lshlrev_b32 v37, 16, v37
    v_cvt_pk_bf16_f32 v51, v48, v37
    v_min_u32 v50, 0xfffffffe, v50
    v_min_u32 v51, 0xfffffffe, v51
    s_lshl_b32 s59, s97, 15
    s_add_u32 s59, s59, 16384
    s_and_saveexec_b64 s[16:17], s[14:15]
    s_cbranch_execz PMh1_nopub
    buffer_store_dwordx2 v[50:51], v70, s[28:31], s59 offen sc1
    s_mov_b64 exec, -1
    v_mov_b32 v40, 0
    v_mov_b32 v41, 1
    s_waitcnt lgkmcnt(0)
    s_mov_b64 exec, 1
    ds_add_u32 v40, v41 offset:42532
    s_mov_b64 exec, -1
PMh1_nopub:
    s_mov_b64 exec, -1
    v_and_b32 v80, 15, v0
    v_bfe_u32 v81, v0, 4, 2
    v_lshrrev_b32 v82, 7, v0
    v_bfe_u32 v83, v0, 6, 1
    v_mul_u32_u24 v82, 21248, v82
    v_lshlrev_b32 v83, 8, v83
    v_sub_u32 v82, v82, v83
    v_sub_u32 v84, 3, v80
    v_and_b32 v84, 3, v84
    v_mul_u32_u24 v85, 4160, v84
    v_add_u32 v86, v80, v84
    v_lshlrev_b32 v87, 3, v81
    v_sub_u32 v86, v87, v86
    v_lshlrev_b32 v86, 1, v86
    v_add3_u32 v86, v86, v85, v82
    v_add_u32 v1, 302, v86
    v_lshlrev_b32 v86, 5, v80
    v_lshl_add_u32 v86, v81, 4, v86
    v_add_u32 v86, v86, v82
    v_add_u32 v2, 16672, v86
    v_lshrrev_b32 v86, 6, v0
    v_mul_u32_u24 v86, 5120, v86
    v_mul_u32_u24 v87, 80, v80
    v_lshlrev_b32 v85, 4, v81
    v_add3_u32 v3, v86, v87, v85
    v_add_u32 v3, 43008, v3
    v_accvgpr_write_b32 a0, 0
    v_accvgpr_write_b32 a1, 0
    v_accvgpr_write_b32 a2, 0
    v_accvgpr_write_b32 a3, 0
    v_accvgpr_write_b32 a4, 0
    v_accvgpr_write_b32 a5, 0
    v_accvgpr_write_b32 a6, 0
    v_accvgpr_write_b32 a7, 0
    v_accvgpr_write_b32 a8, 0
    v_accvgpr_write_b32 a9, 0
    v_accvgpr_write_b32 a10, 0
    v_accvgpr_write_b32 a11, 0
    v_accvgpr_write_b32 a12, 0
    v_accvgpr_write_b32 a13, 0
    v_accvgpr_write_b32 a14, 0
    v_accvgpr_write_b32 a15, 0
    v_accvgpr_write_b32 a16, 0
    v_accvgpr_write_b32 a17, 0
    v_accvgpr_write_b32 a18, 0
    v_accvgpr_write_b32 a19, 0
    v_accvgpr_write_b32 a20, 0
    v_accvgpr_write_b32 a21, 0
    v_accvgpr_write_b32 a22, 0
    v_accvgpr_write_b32 a23, 0
    v_accvgpr_write_b32 a24, 0
    v_accvgpr_write_b32 a25, 0
    v_accvgpr_write_b32 a26, 0
    v_accvgpr_write_b32 a27, 0
    v_accvgpr_write_b32 a28, 0
    v_accvgpr_write_b32 a29, 0
    v_accvgpr_write_b32 a30, 0
    v_accvgpr_write_b32 a31, 0
    s_barrier
    ds_read_b128 v[36:39], v2 offset:448
    ds_read_b64 v[4:5], v1 offset:3776
    ds_read_b64 v[6:7], v1 offset:3784
    ds_read_b64 v[8:9], v1 offset:3264
    ds_read_b64 v[10:11], v1 offset:3272
    ds_read_b64 v[12:13], v1 offset:2752
    ds_read_b64 v[14:15], v1 offset:2760
    ds_read_b64 v[16:17], v1 offset:2240
    ds_read_b64 v[18:19], v1 offset:2248
    ds_read_b128 v[40:43], v2 offset:960
    ds_read_b128 v[44:47], v2 offset:1472
    ds_read_b128 v[48:51], v2 offset:1984
    s_waitcnt lgkmcnt(9)
    v_mfma_f32_16x16x32_f16 a[0:3], v[4:7], v[36:39], a[0:3]
    ds_read_b64 v[20:21], v1 offset:3712
    s_waitcnt lgkmcnt(8)
    v_mfma_f32_16x16x32_f16 a[4:7], v[8:11], v[36:39], a[4:7]
    ds_read_b64 v[22:23], v1 offset:3720
    s_waitcnt lgkmcnt(7)
    v_mfma_f32_16x16x32_f16 a[8:11], v[12:15], v[36:39], a[8:11]
    ds_read_b64 v[24:25], v1 offset:3200
    s_waitcnt lgkmcnt(6)
    v_mfma_f32_16x16x32_f16 a[12:15], v[16:19], v[36:39], a[12:15]
    ds_read_b64 v[26:27], v1 offset:3208
    ds_read_b128 v[36:39], v2 offset:384
    s_waitcnt lgkmcnt(7)
    v_mfma_f32_16x16x32_f16 a[4:7], v[4:7], v[40:43], a[4:7]
    ds_read_b64 v[28:29], v1 offset:2688
    v_mfma_f32_16x16x32_f16 a[8:11], v[8:11], v[40:43], a[8:11]
    ds_read_b64 v[30:31], v1 offset:2696
    v_mfma_f32_16x16x32_f16 a[12:15], v[12:15], v[40:43], a[12:15]
    ds_read_b64 v[32:33], v1 offset:2176
    ds_read_b128 v[40:43], v2 offset:896
    s_waitcnt lgkmcnt(10)
    v_mfma_f32_16x16x32_f16 a[8:11], v[4:7], v[44:47], a[8:11]
    ds_read_b64 v[34:35], v1 offset:2184
    v_mfma_f32_16x16x32_f16 a[12:15], v[8:11], v[44:47], a[12:15]
    ds_read_b128 v[44:47], v2 offset:1408
    s_waitcnt lgkmcnt(11)
    v_mfma_f32_16x16x32_f16 a[12:15], v[4:7], v[48:51], a[12:15]
    ds_read_b128 v[48:51], v2 offset:1920
    s_waitcnt lgkmcnt(7)
    v_mfma_f32_16x16x32_f16 a[0:3], v[20:23], v[36:39], a[0:3]
    ds_read_b64 v[4:5], v1 offset:3648
    v_mfma_f32_16x16x32_f16 a[4:7], v[24:27], v[36:39], a[4:7]
    ds_read_b64 v[6:7], v1 offset:3656
    s_waitcnt lgkmcnt(7)
    v_mfma_f32_16x16x32_f16 a[8:11], v[28:31], v[36:39], a[8:11]
    ds_read_b64 v[8:9], v1 offset:3136
    s_waitcnt lgkmcnt(5)
    v_mfma_f32_16x16x32_f16 a[12:15], v[32:35], v[36:39], a[12:15]
    ds_read_b64 v[10:11], v1 offset:3144
    ds_read_b128 v[36:39], v2 offset:320
    v_mfma_f32_16x16x32_f16 a[4:7], v[20:23], v[40:43], a[4:7]
    ds_read_b64 v[12:13], v1 offset:2624
    v_mfma_f32_16x16x32_f16 a[8:11], v[24:27], v[40:43], a[8:11]
    ds_read_b64 v[14:15], v1 offset:2632
    v_mfma_f32_16x16x32_f16 a[12:15], v[28:31], v[40:43], a[12:15]
    ds_read_b64 v[16:17], v1 offset:2112
    ds_read_b128 v[40:43], v2 offset:832
    s_waitcnt lgkmcnt(10)
    v_mfma_f32_16x16x32_f16 a[8:11], v[20:23], v[44:47], a[8:11]
    ds_read_b64 v[18:19], v1 offset:2120
    v_mfma_f32_16x16x32_f16 a[12:15], v[24:27], v[44:47], a[12:15]
    ds_read_b128 v[44:47], v2 offset:1344
    s_waitcnt lgkmcnt(11)
    v_mfma_f32_16x16x32_f16 a[12:15], v[20:23], v[48:51], a[12:15]
    ds_read_b128 v[48:51], v2 offset:1856
    s_waitcnt lgkmcnt(7)
    v_mfma_f32_16x16x32_f16 a[0:3], v[4:7], v[36:39], a[0:3]
    ds_read_b64 v[20:21], v1 offset:3584
    v_mfma_f32_16x16x32_f16 a[4:7], v[8:11], v[36:39], a[4:7]
    ds_read_b64 v[22:23], v1 offset:3592
    s_waitcnt lgkmcnt(7)
    v_mfma_f32_16x16x32_f16 a[8:11], v[12:15], v[36:39], a[8:11]
    ds_read_b64 v[24:25], v1 offset:3072
    s_waitcnt lgkmcnt(5)
    v_mfma_f32_16x16x32_f16 a[12:15], v[16:19], v[36:39], a[12:15]
    ds_read_b64 v[26:27], v1 offset:3080
    ds_read_b128 v[36:39], v2 offset:256
    v_mfma_f32_16x16x32_f16 a[4:7], v[4:7], v[40:43], a[4:7]
    ds_read_b64 v[28:29], v1 offset:2560
    v_mfma_f32_16x16x32_f16 a[8:11], v[8:11], v[40:43], a[8:11]
    ds_read_b64 v[30:31], v1 offset:2568
    v_mfma_f32_16x16x32_f16 a[12:15], v[12:15], v[40:43], a[12:15]
    ds_read_b64 v[32:33], v1 offset:2048
    ds_read_b128 v[40:43], v2 offset:768
    s_waitcnt lgkmcnt(10)
    v_mfma_f32_16x16x32_f16 a[8:11], v[4:7], v[44:47], a[8:11]
    ds_read_b64 v[34:35], v1 offset:2056
    v_mfma_f32_16x16x32_f16 a[12:15], v[8:11], v[44:47], a[12:15]
    ds_read_b128 v[44:47], v2 offset:1280
    s_waitcnt lgkmcnt(11)
    v_mfma_f32_16x16x32_f16 a[12:15], v[4:7], v[48:51], a[12:15]
    ds_read_b128 v[48:51], v2 offset:1792
    s_waitcnt lgkmcnt(7)
    v_mfma_f32_16x16x32_f16 a[0:3], v[20:23], v[36:39], a[0:3]
    v_mfma_f32_16x16x32_f16 a[4:7], v[24:27], v[36:39], a[4:7]
    s_waitcnt lgkmcnt(5)
    v_mfma_f32_16x16x32_f16 a[8:11], v[28:31], v[36:39], a[8:11]
    s_waitcnt lgkmcnt(2)
    v_mfma_f32_16x16x32_f16 a[12:15], v[32:35], v[36:39], a[12:15]
    v_mfma_f32_16x16x32_f16 a[4:7], v[20:23], v[40:43], a[4:7]
    v_mfma_f32_16x16x32_f16 a[8:11], v[24:27], v[40:43], a[8:11]
    v_mfma_f32_16x16x32_f16 a[12:15], v[28:31], v[40:43], a[12:15]
    s_waitcnt lgkmcnt(1)
    v_mfma_f32_16x16x32_f16 a[8:11], v[20:23], v[44:47], a[8:11]
    v_mfma_f32_16x16x32_f16 a[12:15], v[24:27], v[44:47], a[12:15]
    s_waitcnt lgkmcnt(0)
    v_mfma_f32_16x16x32_f16 a[12:15], v[20:23], v[48:51], a[12:15]
    ds_write_b128 v3, a[0:3] offset:0
    ds_write_b128 v3, a[4:7] offset:1280
    s_nop 2
    ds_write_b128 v3, a[8:11] offset:2560
    s_nop 1
    ds_write_b128 v3, a[12:15] offset:3840
    s_waitcnt lgkmcnt(0)
    ds_read_b128 v[40:43], v2 offset:960
    ds_read_b128 v[44:47], v2 offset:1472
    ds_read_b128 v[48:51], v2 offset:1984
    ds_read_b128 v[52:55], v2 offset:2496
    ds_read_b128 v[56:59], v2 offset:3008
    ds_read_b128 v[60:63], v2 offset:3520
    ds_read_b128 v[64:67], v2 offset:4032
    ds_read_b64 v[4:5], v1 offset:3776
    ds_read_b64 v[6:7], v1 offset:3784
    ds_read_b64 v[8:9], v1 offset:3264
    ds_read_b64 v[10:11], v1 offset:3272
    ds_read_b64 v[12:13], v1 offset:2752
    ds_read_b64 v[14:15], v1 offset:2760
    ds_read_b64 v[16:17], v1 offset:2240
    ds_read_b64 v[18:19], v1 offset:2248
    s_barrier
    s_waitcnt lgkmcnt(0)
    v_mfma_f32_16x16x32_f16 a[16:19], v[16:19], v[40:43], a[16:19]
    ds_read_b64 v[20:21], v1 offset:3712
    ds_read_b128 v[40:43], v2 offset:896
    v_mfma_f32_16x16x32_f16 a[16:19], v[12:15], v[44:47], a[16:19]
    ds_read_b64 v[22:23], v1 offset:3720
    v_mfma_f32_16x16x32_f16 a[20:23], v[16:19], v[44:47], a[20:23]
    ds_read_b64 v[24:25], v1 offset:3200
    ds_read_b128 v[44:47], v2 offset:1408
    v_mfma_f32_16x16x32_f16 a[16:19], v[8:11], v[48:51], a[16:19]
    ds_read_b64 v[26:27], v1 offset:3208
    v_mfma_f32_16x16x32_f16 a[20:23], v[12:15], v[48:51], a[20:23]
    ds_read_b64 v[28:29], v1 offset:2688
    v_mfma_f32_16x16x32_f16 a[24:27], v[16:19], v[48:51], a[24:27]
    ds_read_b64 v[30:31], v1 offset:2696
    ds_read_b128 v[48:51], v2 offset:1920
    v_mfma_f32_16x16x32_f16 a[16:19], v[4:7], v[52:55], a[16:19]
    ds_read_b64 v[32:33], v1 offset:2176
    v_mfma_f32_16x16x32_f16 a[20:23], v[8:11], v[52:55], a[20:23]
    ds_read_b64 v[34:35], v1 offset:2184
    v_mfma_f32_16x16x32_f16 a[24:27], v[12:15], v[52:55], a[24:27]
    v_mfma_f32_16x16x32_f16 a[28:31], v[16:19], v[52:55], a[28:31]
    ds_read_b128 v[52:55], v2 offset:2432
    v_mfma_f32_16x16x32_f16 a[20:23], v[4:7], v[56:59], a[20:23]
    v_mfma_f32_16x16x32_f16 a[24:27], v[8:11], v[56:59], a[24:27]
    v_mfma_f32_16x16x32_f16 a[28:31], v[12:15], v[56:59], a[28:31]
    ds_read_b128 v[56:59], v2 offset:2944
    v_mfma_f32_16x16x32_f16 a[24:27], v[4:7], v[60:63], a[24:27]
    v_mfma_f32_16x16x32_f16 a[28:31], v[8:11], v[60:63], a[28:31]
    ds_read_b128 v[60:63], v2 offset:3456
    v_mfma_f32_16x16x32_f16 a[28:31], v[4:7], v[64:67], a[28:31]
    ds_read_b128 v[64:67], v2 offset:3968
    s_waitcnt lgkmcnt(4)
    v_mfma_f32_16x16x32_f16 a[16:19], v[32:35], v[40:43], a[16:19]
    ds_read_b64 v[4:5], v1 offset:3648
    ds_read_b128 v[40:43], v2 offset:832
    v_mfma_f32_16x16x32_f16 a[16:19], v[28:31], v[44:47], a[16:19]
    ds_read_b64 v[6:7], v1 offset:3656
    v_mfma_f32_16x16x32_f16 a[20:23], v[32:35], v[44:47], a[20:23]
    ds_read_b64 v[8:9], v1 offset:3136
    ds_read_b128 v[44:47], v2 offset:1344
    v_mfma_f32_16x16x32_f16 a[16:19], v[24:27], v[48:51], a[16:19]
    ds_read_b64 v[10:11], v1 offset:3144
    v_mfma_f32_16x16x32_f16 a[20:23], v[28:31], v[48:51], a[20:23]
    ds_read_b64 v[12:13], v1 offset:2624
    v_mfma_f32_16x16x32_f16 a[24:27], v[32:35], v[48:51], a[24:27]
    ds_read_b64 v[14:15], v1 offset:2632
    ds_read_b128 v[48:51], v2 offset:1856
    s_waitcnt lgkmcnt(12)
    v_mfma_f32_16x16x32_f16 a[16:19], v[20:23], v[52:55], a[16:19]
    ds_read_b64 v[16:17], v1 offset:2112
    v_mfma_f32_16x16x32_f16 a[20:23], v[24:27], v[52:55], a[20:23]
    ds_read_b64 v[18:19], v1 offset:2120
    v_mfma_f32_16x16x32_f16 a[24:27], v[28:31], v[52:55], a[24:27]
    v_mfma_f32_16x16x32_f16 a[28:31], v[32:35], v[52:55], a[28:31]
    ds_read_b128 v[52:55], v2 offset:2368
    s_waitcnt lgkmcnt(14)
    v_mfma_f32_16x16x32_f16 a[20:23], v[20:23], v[56:59], a[20:23]
    v_mfma_f32_16x16x32_f16 a[24:27], v[24:27], v[56:59], a[24:27]
    v_mfma_f32_16x16x32_f16 a[28:31], v[28:31], v[56:59], a[28:31]
    ds_read_b128 v[56:59], v2 offset:2880
    s_waitcnt lgkmcnt(14)
    v_mfma_f32_16x16x32_f16 a[24:27], v[20:23], v[60:63], a[24:27]
    v_mfma_f32_16x16x32_f16 a[28:31], v[24:27], v[60:63], a[28:31]
    ds_read_b128 v[60:63], v2 offset:3392
    s_waitcnt lgkmcnt(14)
    v_mfma_f32_16x16x32_f16 a[28:31], v[20:23], v[64:67], a[28:31]
    ds_read_b128 v[64:67], v2 offset:3904
    s_waitcnt lgkmcnt(4)
    v_mfma_f32_16x16x32_f16 a[16:19], v[16:19], v[40:43], a[16:19]
    ds_read_b64 v[20:21], v1 offset:3584
    ds_read_b128 v[40:43], v2 offset:768
    v_mfma_f32_16x16x32_f16 a[16:19], v[12:15], v[44:47], a[16:19]
    ds_read_b64 v[22:23], v1 offset:3592
    v_mfma_f32_16x16x32_f16 a[20:23], v[16:19], v[44:47], a[20:23]
    ds_read_b64 v[24:25], v1 offset:3072
    ds_read_b128 v[44:47], v2 offset:1280
    v_mfma_f32_16x16x32_f16 a[16:19], v[8:11], v[48:51], a[16:19]
    ds_read_b64 v[26:27], v1 offset:3080
    v_mfma_f32_16x16x32_f16 a[20:23], v[12:15], v[48:51], a[20:23]
    ds_read_b64 v[28:29], v1 offset:2560
    v_mfma_f32_16x16x32_f16 a[24:27], v[16:19], v[48:51], a[24:27]
    ds_read_b64 v[30:31], v1 offset:2568
    ds_read_b128 v[48:51], v2 offset:1792
    s_waitcnt lgkmcnt(12)
    v_mfma_f32_16x16x32_f16 a[16:19], v[4:7], v[52:55], a[16:19]
    ds_read_b64 v[32:33], v1 offset:2048
    v_mfma_f32_16x16x32_f16 a[20:23], v[8:11], v[52:55], a[20:23]
    ds_read_b64 v[34:35], v1 offset:2056
    v_mfma_f32_16x16x32_f16 a[24:27], v[12:15], v[52:55], a[24:27]
    v_mfma_f32_16x16x32_f16 a[28:31], v[16:19], v[52:55], a[28:31]
    ds_read_b128 v[52:55], v2 offset:2304
    s_waitcnt lgkmcnt(14)
    v_mfma_f32_16x16x32_f16 a[20:23], v[4:7], v[56:59], a[20:23]
    v_mfma_f32_16x16x32_f16 a[24:27], v[8:11], v[56:59], a[24:27]
    v_mfma_f32_16x16x32_f16 a[28:31], v[12:15], v[56:59], a[28:31]
    ds_read_b128 v[56:59], v2 offset:2816
    s_waitcnt lgkmcnt(14)
    v_mfma_f32_16x16x32_f16 a[24:27], v[4:7], v[60:63], a[24:27]
    v_mfma_f32_16x16x32_f16 a[28:31], v[8:11], v[60:63], a[28:31]
    ds_read_b128 v[60:63], v2 offset:3328
    s_waitcnt lgkmcnt(14)
    v_mfma_f32_16x16x32_f16 a[28:31], v[4:7], v[64:67], a[28:31]
    ds_read_b128 v[64:67], v2 offset:3840
    s_waitcnt lgkmcnt(4)
    v_mfma_f32_16x16x32_f16 a[16:19], v[32:35], v[40:43], a[16:19]
    v_mfma_f32_16x16x32_f16 a[16:19], v[28:31], v[44:47], a[16:19]
    v_mfma_f32_16x16x32_f16 a[20:23], v[32:35], v[44:47], a[20:23]
    v_mfma_f32_16x16x32_f16 a[16:19], v[24:27], v[48:51], a[16:19]
    v_mfma_f32_16x16x32_f16 a[20:23], v[28:31], v[48:51], a[20:23]
    v_mfma_f32_16x16x32_f16 a[24:27], v[32:35], v[48:51], a[24:27]
    s_waitcnt lgkmcnt(3)
    v_mfma_f32_16x16x32_f16 a[16:19], v[20:23], v[52:55], a[16:19]
    v_mfma_f32_16x16x32_f16 a[20:23], v[24:27], v[52:55], a[20:23]
    v_mfma_f32_16x16x32_f16 a[24:27], v[28:31], v[52:55], a[24:27]
    v_mfma_f32_16x16x32_f16 a[28:31], v[32:35], v[52:55], a[28:31]
    s_waitcnt lgkmcnt(2)
    v_mfma_f32_16x16x32_f16 a[20:23], v[20:23], v[56:59], a[20:23]
    v_mfma_f32_16x16x32_f16 a[24:27], v[24:27], v[56:59], a[24:27]
    v_mfma_f32_16x16x32_f16 a[28:31], v[28:31], v[56:59], a[28:31]
    s_waitcnt lgkmcnt(1)
    v_mfma_f32_16x16x32_f16 a[24:27], v[20:23], v[60:63], a[24:27]
    v_mfma_f32_16x16x32_f16 a[28:31], v[24:27], v[60:63], a[28:31]
    s_waitcnt lgkmcnt(0)
    v_mfma_f32_16x16x32_f16 a[28:31], v[20:23], v[64:67], a[28:31]
    ds_read_b128 v[36:39], v2 offset:448
    ds_read_b128 v[40:43], v2 offset:960
    ds_read_b128 v[44:47], v2 offset:1472
    ds_read_b128 v[48:51], v2 offset:1984
    s_barrier
    ds_read_b64 v[4:5], v1 offset:1728
    ds_read_b64 v[6:7], v1 offset:1736
    ds_read_b64 v[8:9], v1 offset:1216
    ds_read_b64 v[10:11], v1 offset:1224
    ds_read_b64 v[12:13], v1 offset:704
    ds_read_b64 v[14:15], v1 offset:712
    ds_read_b64 v[16:17], v1 offset:192
    ds_read_b64 v[18:19], v1 offset:200
    s_waitcnt lgkmcnt(6)
    v_mfma_f32_16x16x32_f16 a[16:19], v[4:7], v[36:39], a[16:19]
    ds_read_b64 v[20:21], v1 offset:1664
    s_waitcnt lgkmcnt(5)
    v_mfma_f32_16x16x32_f16 a[20:23], v[8:11], v[36:39], a[20:23]
    ds_read_b64 v[22:23], v1 offset:1672
    s_waitcnt lgkmcnt(4)
    v_mfma_f32_16x16x32_f16 a[24:27], v[12:15], v[36:39], a[24:27]
    ds_read_b64 v[24:25], v1 offset:1152
    s_waitcnt lgkmcnt(3)
    v_mfma_f32_16x16x32_f16 a[28:31], v[16:19], v[36:39], a[28:31]
    ds_read_b64 v[26:27], v1 offset:1160
    ds_read_b128 v[36:39], v2 offset:384
    v_mfma_f32_16x16x32_f16 a[20:23], v[4:7], v[40:43], a[20:23]
    ds_read_b64 v[28:29], v1 offset:640
    v_mfma_f32_16x16x32_f16 a[24:27], v[8:11], v[40:43], a[24:27]
    ds_read_b64 v[30:31], v1 offset:648
    v_mfma_f32_16x16x32_f16 a[28:31], v[12:15], v[40:43], a[28:31]
    ds_read_b64 v[32:33], v1 offset:128
    ds_read_b128 v[40:43], v2 offset:896
    v_mfma_f32_16x16x32_f16 a[24:27], v[4:7], v[44:47], a[24:27]
    ds_read_b64 v[34:35], v1 offset:136
    v_mfma_f32_16x16x32_f16 a[28:31], v[8:11], v[44:47], a[28:31]
    ds_read_b128 v[44:47], v2 offset:1408
    v_mfma_f32_16x16x32_f16 a[28:31], v[4:7], v[48:51], a[28:31]
    ds_read_b128 v[48:51], v2 offset:1920
    s_waitcnt lgkmcnt(7)
    v_mfma_f32_16x16x32_f16 a[16:19], v[20:23], v[36:39], a[16:19]
    ds_read_b64 v[4:5], v1 offset:1600
    v_mfma_f32_16x16x32_f16 a[20:23], v[24:27], v[36:39], a[20:23]
    ds_read_b64 v[6:7], v1 offset:1608
    s_waitcnt lgkmcnt(7)
    v_mfma_f32_16x16x32_f16 a[24:27], v[28:31], v[36:39], a[24:27]
    ds_read_b64 v[8:9], v1 offset:1088
    s_waitcnt lgkmcnt(5)
    v_mfma_f32_16x16x32_f16 a[28:31], v[32:35], v[36:39], a[28:31]
    ds_read_b64 v[10:11], v1 offset:1096
    ds_read_b128 v[36:39], v2 offset:320
    v_mfma_f32_16x16x32_f16 a[20:23], v[20:23], v[40:43], a[20:23]
    ds_read_b64 v[12:13], v1 offset:576
    v_mfma_f32_16x16x32_f16 a[24:27], v[24:27], v[40:43], a[24:27]
    ds_read_b64 v[14:15], v1 offset:584
    v_mfma_f32_16x16x32_f16 a[28:31], v[28:31], v[40:43], a[28:31]
    ds_read_b64 v[16:17], v1 offset:64
    ds_read_b128 v[40:43], v2 offset:832
    s_waitcnt lgkmcnt(10)
    v_mfma_f32_16x16x32_f16 a[24:27], v[20:23], v[44:47], a[24:27]
    ds_read_b64 v[18:19], v1 offset:72
    v_mfma_f32_16x16x32_f16 a[28:31], v[24:27], v[44:47], a[28:31]
    ds_read_b128 v[44:47], v2 offset:1344
    s_waitcnt lgkmcnt(11)
    v_mfma_f32_16x16x32_f16 a[28:31], v[20:23], v[48:51], a[28:31]
    ds_read_b128 v[48:51], v2 offset:1856
    s_waitcnt lgkmcnt(7)
    v_mfma_f32_16x16x32_f16 a[16:19], v[4:7], v[36:39], a[16:19]
    ds_read_b64 v[20:21], v1 offset:1536
    v_mfma_f32_16x16x32_f16 a[20:23], v[8:11], v[36:39], a[20:23]
    ds_read_b64 v[22:23], v1 offset:1544
    s_waitcnt lgkmcnt(7)
    v_mfma_f32_16x16x32_f16 a[24:27], v[12:15], v[36:39], a[24:27]
    ds_read_b64 v[24:25], v1 offset:1024
    s_waitcnt lgkmcnt(5)
    v_mfma_f32_16x16x32_f16 a[28:31], v[16:19], v[36:39], a[28:31]
    ds_read_b64 v[26:27], v1 offset:1032
    ds_read_b128 v[36:39], v2 offset:256
    v_mfma_f32_16x16x32_f16 a[20:23], v[4:7], v[40:43], a[20:23]
    ds_read_b64 v[28:29], v1 offset:512
    v_mfma_f32_16x16x32_f16 a[24:27], v[8:11], v[40:43], a[24:27]
    ds_read_b64 v[30:31], v1 offset:520
    v_mfma_f32_16x16x32_f16 a[28:31], v[12:15], v[40:43], a[28:31]
    ds_read_b64 v[32:33], v1 offset:0
    ds_read_b128 v[40:43], v2 offset:768
    s_waitcnt lgkmcnt(10)
    v_mfma_f32_16x16x32_f16 a[24:27], v[4:7], v[44:47], a[24:27]
    ds_read_b64 v[34:35], v1 offset:8
    v_mfma_f32_16x16x32_f16 a[28:31], v[8:11], v[44:47], a[28:31]
    ds_read_b128 v[44:47], v2 offset:1280
    s_waitcnt lgkmcnt(11)
    v_mfma_f32_16x16x32_f16 a[28:31], v[4:7], v[48:51], a[28:31]
    ds_read_b128 v[48:51], v2 offset:1792
    s_waitcnt lgkmcnt(7)
    v_mfma_f32_16x16x32_f16 a[16:19], v[20:23], v[36:39], a[16:19]
    v_mfma_f32_16x16x32_f16 a[20:23], v[24:27], v[36:39], a[20:23]
    s_waitcnt lgkmcnt(5)
    v_mfma_f32_16x16x32_f16 a[24:27], v[28:31], v[36:39], a[24:27]
    s_waitcnt lgkmcnt(2)
    v_mfma_f32_16x16x32_f16 a[28:31], v[32:35], v[36:39], a[28:31]
    v_mfma_f32_16x16x32_f16 a[20:23], v[20:23], v[40:43], a[20:23]
    v_mfma_f32_16x16x32_f16 a[24:27], v[24:27], v[40:43], a[24:27]
    v_mfma_f32_16x16x32_f16 a[28:31], v[28:31], v[40:43], a[28:31]
    s_waitcnt lgkmcnt(1)
    v_mfma_f32_16x16x32_f16 a[24:27], v[20:23], v[44:47], a[24:27]
    v_mfma_f32_16x16x32_f16 a[28:31], v[24:27], v[44:47], a[28:31]
    s_waitcnt lgkmcnt(0)
    v_mfma_f32_16x16x32_f16 a[28:31], v[20:23], v[48:51], a[28:31]
    s_cmp_eq_u32 s97, 0
    s_cbranch_scc0 PM_nohk
    buffer_load_dwordx4 v[88:91], v71, s[20:23], 0 offen sc1
PM_nohk:
    ds_write_b128 v3, a[16:19] offset:0
    ds_write_b128 v3, a[20:23] offset:1280
    ds_write_b128 v3, a[24:27] offset:2560
    s_nop 1
    ds_write_b128 v3, a[28:31] offset:3840
    s_waitcnt lgkmcnt(0)
    s_barrier
    s_add_u32 s97, s97, 1
    s_cmp_lt_u32 s97, 2
    s_cbranch_scc1 PM_loop
    s_endpgm
F1_H:
    s_load_dwordx8 s[4:11], s[0:1], 0
    s_load_dwordx4 s[60:63], s[0:1], 32
    s_load_dwordx4 s[12:15], s[0:1], 112
    s_memrealtime s[92:93]
    s_lshr_b32 s17, s3, 5
    s_and_b32 s18, s3, 31
    v_and_b32 v1, 31, v0
    v_lshrrev_b32 v3, 5, v0
    s_lshl_b32 s19, s17, 5
    v_add_u32 v1, s19, v1
    s_lshl_b32 s19, s18, 16
    v_lshlrev_b32 v90, 13, v3
    v_lshl_add_u32 v90, v1, 2, v90
    v_add_u32 v90, s19, v90
    v_subrev_u32 v4, 3072, v90
    v_cmp_gt_i32 vcc, 0, v4
    s_nop 1
    v_cndmask_b32 v4, v4, 2.0, vcc
    v_lshlrev_b32 v5, 4, v1
    s_mov_b32 s19, 8320
    v_mul_lo_u32 v91, v1, s19
    s_lshl_b32 s19, s18, 8
    v_lshl_add_u32 v91, v3, 5, v91
    v_add_u32 v91, s19, v91
    s_movk_i32 s16, 0x1000
    s_mul_i32 s84, s3, 8320
    s_lshl_b32 s85, s3, 13
    s_add_u32 s86, s85, 4096
    s_lshl_b32 s87, s3, 2
    s_add_u32 s83, s84, 4096
    v_lshlrev_b32 v2, 4, v0
    s_waitcnt lgkmcnt(0)
    s_mov_b32 s20, s4
    s_mov_b32 s21, s5
    s_mov_b32 s22, 0x200000
    s_mov_b32 s23, 0x20000
    s_mov_b32 s24, s6
    s_mov_b32 s25, s7
    s_mov_b32 s26, 0x200000
    s_mov_b32 s27, 0x20000
    s_mov_b32 s28, s8
    s_mov_b32 s29, s9
    s_mov_b32 s30, 0x200000
    s_mov_b32 s31, 0x20000
    s_mov_b32 s32, s10
    s_mov_b32 s33, s11
    s_mov_b32 s34, 0x1000
    s_mov_b32 s35, 0x20000
    buffer_load_dwordx4 v[26:29], v5, s[32:35], 0 offen
    buffer_load_dword v6, v4, s[24:27], 0 offen offset:0
    buffer_load_dword v7, v4, s[24:27], 0 offen offset:1024
    buffer_load_dword v8, v4, s[24:27], 0 offen offset:2048
    buffer_load_dword v9, v90, s[24:27], 0 offen offset:0
    buffer_load_dword v10, v90, s[24:27], 0 offen offset:1024
    buffer_load_dword v11, v90, s[24:27], 0 offen offset:2048
    buffer_load_dword v12, v90, s[24:27], 0 offen offset:3072
    buffer_load_dword v13, v90, s[24:27], s16 offen offset:0
    buffer_load_dword v14, v90, s[24:27], s16 offen offset:1024
    buffer_load_dword v15, v90, s[24:27], s16 offen offset:2048
    buffer_load_dword v16, v90, s[24:27], s16 offen offset:3072
    buffer_load_dword v18, v90, s[28:31], 0 offen offset:0
    buffer_load_dword v19, v90, s[28:31], 0 offen offset:1024
    buffer_load_dword v20, v90, s[28:31], 0 offen offset:2048
    buffer_load_dword v21, v90, s[28:31], 0 offen offset:3072
    buffer_load_dword v22, v90, s[28:31], s16 offen offset:0
    buffer_load_dword v23, v90, s[28:31], s16 offen offset:1024
    buffer_load_dword v24, v90, s[28:31], s16 offen offset:2048
    buffer_load_dword v25, v90, s[28:31], s16 offen offset:3072
    s_mov_b32 s44, s12
    s_mov_b32 s45, s13
    s_mov_b32 s46, 0x100
    s_mov_b32 s47, 0x20000
    v_readfirstlane_b32 s94, v0
    s_or_b32 s92, s92, 1
    s_lshl_b32 s19, s17, 5
    v_mov_b32 v86, s92
    v_mov_b32 v87, s93
    v_mov_b32 v88, 0
    v_mov_b32 v89, 0
    v_mov_b32 v92, s19
    s_mov_b64 exec, 1
    s_cmp_ge_u32 s94, 64
    s_cbranch_scc1 F1_dummy
    buffer_atomic_cmpswap_x2 v[86:89], v92, s[44:47], 0 offen sc0 sc1
    s_branch F1_tagi
F1_dummy:
    buffer_load_dword v86, v5, s[32:35], 0 offen
F1_tagi:
    s_mov_b64 exec, -1
    s_setprio 3
    s_barrier
    s_mov_b32 s36, s14
    s_mov_b32 s37, s15
    s_mov_b32 s38, 0x208000
    s_mov_b32 s39, 0x20000
    s_add_u32 s56, s14, 0x400000
    s_addc_u32 s57, s15, 0
    s_mov_b32 s58, 0x208000
    s_mov_b32 s59, 0x20000
    s_mov_b32 s44, s60
    s_mov_b32 s45, s61
    s_mov_b32 s46, 0x200000
    s_mov_b32 s47, 0x20000
    s_mov_b32 s48, s62
    s_mov_b32 s49, s63
    s_mov_b32 s50, 0x400
    s_mov_b32 s51, 0x20000
    s_add_u32 s52, s14, 0x1420000
    s_addc_u32 s53, s15, 0
    s_mov_b32 s54, 0x10000
    s_mov_b32 s55, 0x20000
    s_waitcnt vmcnt(20)
    v_lshlrev_b32 v52, 16, v26
    v_lshlrev_b32 v53, 16, v28
    v_and_b32 v54, 0xffff0000, v26
    v_and_b32 v55, 0xffff0000, v28
    v_lshlrev_b32 v56, 16, v27
    v_lshlrev_b32 v57, 16, v29
    v_and_b32 v58, 0xffff0000, v27
    v_and_b32 v59, 0xffff0000, v29
    s_waitcnt vmcnt(9)
    v_lshlrev_b32 v30, 16, v6
    v_and_b32 v31, 0xffff0000, v6
    v_lshlrev_b32 v32, 16, v7
    v_and_b32 v33, 0xffff0000, v7
    v_lshlrev_b32 v34, 16, v8
    v_and_b32 v35, 0xffff0000, v8
    v_lshlrev_b32 v36, 16, v9
    v_and_b32 v37, 0xffff0000, v9
    v_lshlrev_b32 v38, 16, v10
    v_and_b32 v39, 0xffff0000, v10
    v_lshlrev_b32 v40, 16, v11
    v_and_b32 v41, 0xffff0000, v11
    v_lshlrev_b32 v42, 16, v12
    v_and_b32 v43, 0xffff0000, v12
    v_lshlrev_b32 v44, 16, v13
    v_and_b32 v45, 0xffff0000, v13
    v_lshlrev_b32 v46, 16, v14
    v_and_b32 v47, 0xffff0000, v14
    v_lshlrev_b32 v48, 16, v15
    v_and_b32 v49, 0xffff0000, v15
    v_lshlrev_b32 v50, 16, v16
    v_and_b32 v51, 0xffff0000, v16
    s_waitcnt vmcnt(1)
    v_pk_mul_f32 v[60:61], v[30:31], v[58:59]
    v_pk_mul_f32 v[66:67], v[32:33], v[58:59]
    v_pk_mul_f32 v[72:73], v[34:35], v[58:59]
    v_pk_mul_f32 v[78:79], v[36:37], v[58:59]
    v_cvt_pk_bf16_f32 v64, v60, v61
    v_cvt_pk_bf16_f32 v70, v66, v67
    v_cvt_pk_bf16_f32 v76, v72, v73
    v_cvt_pk_bf16_f32 v82, v78, v79
    v_lshlrev_b32 v60, 16, v64
    v_lshlrev_b32 v66, 16, v70
    v_lshlrev_b32 v72, 16, v76
    v_lshlrev_b32 v78, 16, v82
    v_and_b32 v61, 0xffff0000, v64
    v_and_b32 v67, 0xffff0000, v70
    v_and_b32 v73, 0xffff0000, v76
    v_and_b32 v79, 0xffff0000, v82
    v_pk_mul_f32 v[62:63], v[32:33], v[56:57]
    v_pk_mul_f32 v[68:69], v[34:35], v[56:57]
    v_pk_mul_f32 v[74:75], v[36:37], v[56:57]
    v_pk_mul_f32 v[80:81], v[38:39], v[56:57]
    v_cvt_pk_bf16_f32 v64, v62, v63
    v_cvt_pk_bf16_f32 v70, v68, v69
    v_cvt_pk_bf16_f32 v76, v74, v75
    v_cvt_pk_bf16_f32 v82, v80, v81
    v_lshlrev_b32 v62, 16, v64
    v_lshlrev_b32 v68, 16, v70
    v_lshlrev_b32 v74, 16, v76
    v_lshlrev_b32 v80, 16, v82
    v_and_b32 v63, 0xffff0000, v64
    v_and_b32 v69, 0xffff0000, v70
    v_and_b32 v75, 0xffff0000, v76
    v_and_b32 v81, 0xffff0000, v82
    v_pk_add_f32 v[60:61], v[60:61], v[62:63]
    v_pk_add_f32 v[66:67], v[66:67], v[68:69]
    v_pk_add_f32 v[72:73], v[72:73], v[74:75]
    v_pk_add_f32 v[78:79], v[78:79], v[80:81]
    v_cvt_pk_bf16_f32 v64, v60, v61
    v_cvt_pk_bf16_f32 v70, v66, v67
    v_cvt_pk_bf16_f32 v76, v72, v73
    v_cvt_pk_bf16_f32 v82, v78, v79
    v_lshlrev_b32 v60, 16, v64
    v_lshlrev_b32 v66, 16, v70
    v_lshlrev_b32 v72, 16, v76
    v_lshlrev_b32 v78, 16, v82
    v_and_b32 v61, 0xffff0000, v64
    v_and_b32 v67, 0xffff0000, v70
    v_and_b32 v73, 0xffff0000, v76
    v_and_b32 v79, 0xffff0000, v82
    v_pk_mul_f32 v[62:63], v[34:35], v[54:55]
    v_pk_mul_f32 v[68:69], v[36:37], v[54:55]
    v_pk_mul_f32 v[74:75], v[38:39], v[54:55]
    v_pk_mul_f32 v[80:81], v[40:41], v[54:55]
    v_cvt_pk_bf16_f32 v64, v62, v63
    v_cvt_pk_bf16_f32 v70, v68, v69
    v_cvt_pk_bf16_f32 v76, v74, v75
    v_cvt_pk_bf16_f32 v82, v80, v81
    v_lshlrev_b32 v62, 16, v64
    v_lshlrev_b32 v68, 16, v70
    v_lshlrev_b32 v74, 16, v76
    v_lshlrev_b32 v80, 16, v82
    v_and_b32 v63, 0xffff0000, v64
    v_and_b32 v69, 0xffff0000, v70
    v_and_b32 v75, 0xffff0000, v76
    v_and_b32 v81, 0xffff0000, v82
    v_pk_add_f32 v[60:61], v[60:61], v[62:63]
    v_pk_add_f32 v[66:67], v[66:67], v[68:69]
    v_pk_add_f32 v[72:73], v[72:73], v[74:75]
    v_pk_add_f32 v[78:79], v[78:79], v[80:81]
    v_cvt_pk_bf16_f32 v64, v60, v61
    v_cvt_pk_bf16_f32 v70, v66, v67
    v_cvt_pk_bf16_f32 v76, v72, v73
    v_cvt_pk_bf16_f32 v82, v78, v79
    v_lshlrev_b32 v60, 16, v64
    v_lshlrev_b32 v66, 16, v70
    v_lshlrev_b32 v72, 16, v76
    v_lshlrev_b32 v78, 16, v82
    v_and_b32 v61, 0xffff0000, v64
    v_and_b32 v67, 0xffff0000, v70
    v_and_b32 v73, 0xffff0000, v76
    v_and_b32 v79, 0xffff0000, v82
    v_pk_mul_f32 v[62:63], v[36:37], v[52:53]
    v_pk_mul_f32 v[68:69], v[38:39], v[52:53]
    v_pk_mul_f32 v[74:75], v[40:41], v[52:53]
    v_pk_mul_f32 v[80:81], v[42:43], v[52:53]
    v_cvt_pk_bf16_f32 v64, v62, v63
    v_cvt_pk_bf16_f32 v70, v68, v69
    v_cvt_pk_bf16_f32 v76, v74, v75
    v_cvt_pk_bf16_f32 v82, v80, v81
    v_lshlrev_b32 v62, 16, v64
    v_lshlrev_b32 v68, 16, v70
    v_lshlrev_b32 v74, 16, v76
    v_lshlrev_b32 v80, 16, v82
    v_and_b32 v63, 0xffff0000, v64
    v_and_b32 v69, 0xffff0000, v70
    v_and_b32 v75, 0xffff0000, v76
    v_and_b32 v81, 0xffff0000, v82
    v_pk_add_f32 v[60:61], v[60:61], v[62:63]
    v_pk_add_f32 v[66:67], v[66:67], v[68:69]
    v_pk_add_f32 v[72:73], v[72:73], v[74:75]
    v_pk_add_f32 v[78:79], v[78:79], v[80:81]
    v_cvt_pk_bf16_f32 v64, v60, v61
    v_cvt_pk_bf16_f32 v70, v66, v67
    v_cvt_pk_bf16_f32 v76, v72, v73
    v_cvt_pk_bf16_f32 v82, v78, v79
    v_lshlrev_b32 v60, 16, v64
    v_lshlrev_b32 v66, 16, v70
    v_lshlrev_b32 v72, 16, v76
    v_lshlrev_b32 v78, 16, v82
    v_and_b32 v61, 0xffff0000, v64
    v_and_b32 v67, 0xffff0000, v70
    v_and_b32 v73, 0xffff0000, v76
    v_and_b32 v79, 0xffff0000, v82
    v_lshlrev_b32 v62, 16, v18
    v_lshlrev_b32 v68, 16, v19
    v_lshlrev_b32 v74, 16, v20
    v_lshlrev_b32 v80, 16, v21
    v_and_b32 v63, 0xffff0000, v18
    v_and_b32 v69, 0xffff0000, v19
    v_and_b32 v75, 0xffff0000, v20
    v_and_b32 v81, 0xffff0000, v21
    v_pk_mul_f32 v[60:61], v[60:61], v[62:63]
    v_pk_mul_f32 v[66:67], v[66:67], v[68:69]
    v_pk_mul_f32 v[72:73], v[72:73], v[74:75]
    v_pk_mul_f32 v[78:79], v[78:79], v[80:81]
    v_cvt_pk_bf16_f32 v6, v60, v61
    v_cvt_pk_bf16_f32 v7, v66, v67
    v_cvt_pk_bf16_f32 v8, v72, v73
    v_cvt_pk_bf16_f32 v9, v78, v79
    v_pk_mul_f32 v[60:61], v[38:39], v[58:59]
    v_pk_mul_f32 v[66:67], v[40:41], v[58:59]
    v_pk_mul_f32 v[72:73], v[42:43], v[58:59]
    v_pk_mul_f32 v[78:79], v[44:45], v[58:59]
    v_cvt_pk_bf16_f32 v64, v60, v61
    v_cvt_pk_bf16_f32 v70, v66, v67
    v_cvt_pk_bf16_f32 v76, v72, v73
    v_cvt_pk_bf16_f32 v82, v78, v79
    v_lshlrev_b32 v60, 16, v64
    v_lshlrev_b32 v66, 16, v70
    v_lshlrev_b32 v72, 16, v76
    v_lshlrev_b32 v78, 16, v82
    v_and_b32 v61, 0xffff0000, v64
    v_and_b32 v67, 0xffff0000, v70
    v_and_b32 v73, 0xffff0000, v76
    v_and_b32 v79, 0xffff0000, v82
    v_pk_mul_f32 v[62:63], v[40:41], v[56:57]
    v_pk_mul_f32 v[68:69], v[42:43], v[56:57]
    v_pk_mul_f32 v[74:75], v[44:45], v[56:57]
    v_pk_mul_f32 v[80:81], v[46:47], v[56:57]
    v_cvt_pk_bf16_f32 v64, v62, v63
    v_cvt_pk_bf16_f32 v70, v68, v69
    v_cvt_pk_bf16_f32 v76, v74, v75
    v_cvt_pk_bf16_f32 v82, v80, v81
    v_lshlrev_b32 v62, 16, v64
    v_lshlrev_b32 v68, 16, v70
    v_lshlrev_b32 v74, 16, v76
    v_lshlrev_b32 v80, 16, v82
    v_and_b32 v63, 0xffff0000, v64
    v_and_b32 v69, 0xffff0000, v70
    v_and_b32 v75, 0xffff0000, v76
    v_and_b32 v81, 0xffff0000, v82
    v_pk_add_f32 v[60:61], v[60:61], v[62:63]
    v_pk_add_f32 v[66:67], v[66:67], v[68:69]
    v_pk_add_f32 v[72:73], v[72:73], v[74:75]
    v_pk_add_f32 v[78:79], v[78:79], v[80:81]
    v_cvt_pk_bf16_f32 v64, v60, v61
    v_cvt_pk_bf16_f32 v70, v66, v67
    v_cvt_pk_bf16_f32 v76, v72, v73
    v_cvt_pk_bf16_f32 v82, v78, v79
    v_lshlrev_b32 v60, 16, v64
    v_lshlrev_b32 v66, 16, v70
    v_lshlrev_b32 v72, 16, v76
    v_lshlrev_b32 v78, 16, v82
    v_and_b32 v61, 0xffff0000, v64
    v_and_b32 v67, 0xffff0000, v70
    v_and_b32 v73, 0xffff0000, v76
    v_and_b32 v79, 0xffff0000, v82
    v_pk_mul_f32 v[62:63], v[42:43], v[54:55]
    v_pk_mul_f32 v[68:69], v[44:45], v[54:55]
    v_pk_mul_f32 v[74:75], v[46:47], v[54:55]
    v_pk_mul_f32 v[80:81], v[48:49], v[54:55]
    v_cvt_pk_bf16_f32 v64, v62, v63
    v_cvt_pk_bf16_f32 v70, v68, v69
    v_cvt_pk_bf16_f32 v76, v74, v75
    v_cvt_pk_bf16_f32 v82, v80, v81
    v_lshlrev_b32 v62, 16, v64
    v_lshlrev_b32 v68, 16, v70
    v_lshlrev_b32 v74, 16, v76
    v_lshlrev_b32 v80, 16, v82
    v_and_b32 v63, 0xffff0000, v64
    v_and_b32 v69, 0xffff0000, v70
    v_and_b32 v75, 0xffff0000, v76
    v_and_b32 v81, 0xffff0000, v82
    v_pk_add_f32 v[60:61], v[60:61], v[62:63]
    v_pk_add_f32 v[66:67], v[66:67], v[68:69]
    v_pk_add_f32 v[72:73], v[72:73], v[74:75]
    v_pk_add_f32 v[78:79], v[78:79], v[80:81]
    v_cvt_pk_bf16_f32 v64, v60, v61
    v_cvt_pk_bf16_f32 v70, v66, v67
    v_cvt_pk_bf16_f32 v76, v72, v73
    v_cvt_pk_bf16_f32 v82, v78, v79
    v_lshlrev_b32 v60, 16, v64
    v_lshlrev_b32 v66, 16, v70
    v_lshlrev_b32 v72, 16, v76
    v_lshlrev_b32 v78, 16, v82
    v_and_b32 v61, 0xffff0000, v64
    v_and_b32 v67, 0xffff0000, v70
    v_and_b32 v73, 0xffff0000, v76
    v_and_b32 v79, 0xffff0000, v82
    v_pk_mul_f32 v[62:63], v[44:45], v[52:53]
    v_pk_mul_f32 v[68:69], v[46:47], v[52:53]
    v_pk_mul_f32 v[74:75], v[48:49], v[52:53]
    v_pk_mul_f32 v[80:81], v[50:51], v[52:53]
    v_cvt_pk_bf16_f32 v64, v62, v63
    v_cvt_pk_bf16_f32 v70, v68, v69
    v_cvt_pk_bf16_f32 v76, v74, v75
    v_cvt_pk_bf16_f32 v82, v80, v81
    v_lshlrev_b32 v62, 16, v64
    v_lshlrev_b32 v68, 16, v70
    v_lshlrev_b32 v74, 16, v76
    v_lshlrev_b32 v80, 16, v82
    v_and_b32 v63, 0xffff0000, v64
    v_and_b32 v69, 0xffff0000, v70
    v_and_b32 v75, 0xffff0000, v76
    v_and_b32 v81, 0xffff0000, v82
    v_pk_add_f32 v[60:61], v[60:61], v[62:63]
    v_pk_add_f32 v[66:67], v[66:67], v[68:69]
    v_pk_add_f32 v[72:73], v[72:73], v[74:75]
    v_pk_add_f32 v[78:79], v[78:79], v[80:81]
    v_cvt_pk_bf16_f32 v64, v60, v61
    v_cvt_pk_bf16_f32 v70, v66, v67
    v_cvt_pk_bf16_f32 v76, v72, v73
    v_cvt_pk_bf16_f32 v82, v78, v79
    v_lshlrev_b32 v60, 16, v64
    v_lshlrev_b32 v66, 16, v70
    v_lshlrev_b32 v72, 16, v76
    v_lshlrev_b32 v78, 16, v82
    v_and_b32 v61, 0xffff0000, v64
    v_and_b32 v67, 0xffff0000, v70
    v_and_b32 v73, 0xffff0000, v76
    v_and_b32 v79, 0xffff0000, v82
    v_lshlrev_b32 v62, 16, v22
    v_lshlrev_b32 v68, 16, v23
    v_lshlrev_b32 v74, 16, v24
    v_lshlrev_b32 v80, 16, v25
    v_and_b32 v63, 0xffff0000, v22
    v_and_b32 v69, 0xffff0000, v23
    v_and_b32 v75, 0xffff0000, v24
    v_and_b32 v81, 0xffff0000, v25
    v_pk_mul_f32 v[60:61], v[60:61], v[62:63]
    v_pk_mul_f32 v[66:67], v[66:67], v[68:69]
    v_pk_mul_f32 v[72:73], v[72:73], v[74:75]
    v_pk_mul_f32 v[78:79], v[78:79], v[80:81]
    v_cvt_pk_bf16_f32 v10, v60, v61
    v_cvt_pk_bf16_f32 v11, v66, v67
    v_cvt_pk_bf16_f32 v12, v72, v73
    v_cvt_pk_bf16_f32 v13, v78, v79
    v_and_b32 v60, 31, v0
    v_mul_u32_u24 v60, 272, v60
    v_lshl_add_u32 v60, v3, 5, v60
    ds_write_b128 v60, v[6:9]
    ds_write_b128 v60, v[10:13] offset:16
    v_lshrrev_b32 v61, 4, v0
    v_and_b32 v62, 15, v0
    v_mul_u32_u24 v63, 272, v61
    v_lshl_add_u32 v63, v62, 4, v63
    s_lshl_b32 s88, s17, 5
    v_add_u32 v61, s88, v61
    s_mov_b32 s88, 8320
    v_mul_lo_u32 v61, v61, s88
    v_lshl_add_u32 v61, v62, 4, v61
    s_and_b32 s88, s3, 31
    s_lshl_b32 s88, s88, 8
    v_add_u32 v61, s88, v61
    s_mov_b32 s89, 133120
    v_mov_b32 v64, 0
    v_mov_b32 v65, 1
    s_waitcnt lgkmcnt(0)
    s_mov_b64 exec, 1
    ds_add_u32 v64, v65 offset:42516
    s_mov_b64 exec, -1
F1_hbar:
    ds_read_b32 v65, v64 offset:42516
    s_waitcnt lgkmcnt(0)
    v_readfirstlane_b32 s88, v65
    s_cmp_lt_u32 s88, 4
    s_cbranch_scc1 F1_hbar
    ds_read_b128 v[6:9], v63
    ds_read_b128 v[10:13], v63 offset:4352
    s_waitcnt lgkmcnt(0)
    buffer_store_dwordx4 v[6:9], v61, s[36:39], 0 offen sc1
    buffer_store_dwordx4 v[10:13], v61, s[36:39], s89 offen sc1
    s_lshl_b32 s88, s17, 5
    v_mov_b32 v92, s88
    v_mov_b32 v93, 1
    v_and_b32 v94, 63, v0
    v_cmp_eq_u32 vcc, 0, v94
    s_waitcnt vmcnt(0)
    s_and_saveexec_b64 s[18:19], vcc
    s_cmp_ge_u32 s94, 64
    s_cbranch_scc1 F1_tagw
    v_readfirstlane_b32 s88, v86
    v_readfirstlane_b32 s89, v87
    s_cmp_eq_u32 s88, 0
    s_cselect_b32 s88, s92, s88
    s_cselect_b32 s89, s93, s89
    v_mov_b32 v86, s88
    v_mov_b32 v87, s89
    ds_write_b64 v94, v[86:87] offset:42520
F1_tagw:
    ds_add_rtn_u32 v94, v94, v93 offset:42496
    s_waitcnt lgkmcnt(0)
    v_readfirstlane_b32 s88, v94
    s_mov_b64 exec, s[18:19]
    s_cmp_lg_u32 s88, 3
    s_cbranch_scc1 F1_nosig
    v_mov_b32 v94, 0
F1_tag1:
    ds_read_b64 v[92:93], v94 offset:42520
    s_waitcnt lgkmcnt(0)
    v_readfirstlane_b32 s88, v92
    s_cmp_eq_u32 s88, 0
    s_cbranch_scc1 F1_tag1
    s_lshl_b32 s88, s17, 13
    s_and_b32 s89, s3, 31
    s_lshl_b32 s89, s89, 3
    s_add_u32 s88, s88, s89
    v_and_b32 v94, 31, v0
    v_lshlrev_b32 v94, 8, v94
    s_mov_b64 exec, 0xffffffff
    buffer_store_dwordx2 v[92:93], v94, s[52:55], s88 offen sc1
    s_mov_b64 exec, -1
F1_nosig:
    s_setprio 0
    buffer_load_dwordx4 v[34:37], v2, s[44:47], s85 offen
    buffer_load_dwordx4 v[38:41], v2, s[44:47], s86 offen
    v_mov_b32 v5, s87
    buffer_load_dword v8, v5, s[48:51], 0 offen
    buffer_load_dword v18, v90, s[20:23], 0 offen offset:0
    buffer_load_dword v19, v90, s[20:23], 0 offen offset:1024
    buffer_load_dword v20, v90, s[20:23], 0 offen offset:2048
    buffer_load_dword v21, v90, s[20:23], 0 offen offset:3072
    buffer_load_dword v22, v90, s[20:23], s16 offen offset:0
    buffer_load_dword v23, v90, s[20:23], s16 offen offset:1024
    buffer_load_dword v24, v90, s[20:23], s16 offen offset:2048
    buffer_load_dword v25, v90, s[20:23], s16 offen offset:3072
    v_lshrrev_b32 v50, 2, v0
    v_mul_u32_u24 v50, 80, v50
    v_and_b32 v51, 3, v0
    v_lshl_add_u32 v4, v51, 4, v50
    v_add_u32 v4, 43008, v4
    v_lshlrev_b32 v3, 3, v0
    v_sub_u32 v3, 2056, v3
    s_mov_b32 s40, 0x05040100
    s_mov_b32 s41, 0x07060302
    v_mov_b32 v50, 0
    v_mov_b32 v51, 0
    v_mov_b32 v52, 0
    v_mov_b32 v53, 0
    v_and_b32 v54, 31, v0
    v_lshlrev_b32 v54, 4, v54
    v_lshrrev_b32 v55, 5, v0
    v_and_b32 v56, 1, v55
    v_lshrrev_b32 v57, 1, v55
    v_mul_u32_u24 v56, 21248, v56
    v_mul_u32_u24 v57, 4608, v57
    v_add3_u32 v54, v54, v56, v57
    v_cmp_gt_u32 vcc, 64, v0
    s_and_saveexec_b64 s[18:19], vcc
    ds_write_b128 v54, v[50:53] offset:16640
    s_mov_b64 exec, s[18:19]
    s_waitcnt vmcnt(8)
    ds_write_b128 v2, v[34:37] offset:17152
    ds_write_b128 v2, v[38:41] offset:38400
    v_lshlrev_b32 v6, 16, v8
    v_and_b32 v7, 0xffff0000, v8
    s_add_u32 s24, s14, 0x800000
    s_addc_u32 s25, s15, 0
    s_mov_b32 s26, 0x208000
    s_mov_b32 s27, 0x20000
    v_mov_b32 v94, 0
    v_readfirstlane_b32 s88, v0
    s_cmp_ge_u32 s88, 64
    s_cbranch_scc1 F1_wait
    s_mov_b32 s89, 0
F1_tag2:
    ds_read_b64 v[86:87], v94 offset:42520
    s_waitcnt lgkmcnt(0)
    v_readfirstlane_b32 s88, v86
    s_cmp_eq_u32 s88, 0
    s_cbranch_scc1 F1_tag2
    v_and_b32 v88, 31, v0
    v_lshlrev_b32 v88, 3, v88
    s_lshl_b32 s88, s3, 8
F1_poll:
    buffer_load_dwordx2 v[92:93], v88, s[52:55], s88 offen sc1
    s_waitcnt vmcnt(0)
    s_add_u32 s89, s89, 1
    v_cmp_ne_u64 vcc, v[86:87], v[92:93]
    s_cbranch_vccz F1_got
    s_sleep 2
    s_cmp_lt_u32 s89, 1048576
    s_cbranch_scc1 F1_poll
F1_got:
    v_mov_b32 v93, 1
    ds_write_b32 v94, v93 offset:42512
    s_branch F1_go
F1_wait:
    s_sleep 1
    ds_read_b32 v93, v94 offset:42512
    s_waitcnt lgkmcnt(0)
    v_readfirstlane_b32 s88, v93
    s_cmp_eq_u32 s88, 0
    s_cbranch_scc1 F1_wait
F1_go:
    buffer_load_dwordx4 v[10:13], v2, s[36:39], s84 offen sc1
    buffer_load_dwordx4 v[14:17], v2, s[36:39], s83 offen sc1
    v_mov_b32 v50, 0
    v_mov_b32 v51, 0
    v_mov_b32 v52, 0
    v_mov_b32 v53, 0
    v_lshrrev_b32 v55, 2, v0
    v_and_b32 v56, 3, v55
    v_lshrrev_b32 v57, 2, v55
    v_mul_u32_u24 v56, 4160, v56
    v_mul_u32_u24 v57, 21248, v57
    v_and_b32 v54, 3, v0
    v_lshlrev_b32 v54, 4, v54
    v_add3_u32 v54, v54, v56, v57
    v_cmp_gt_u32 vcc, 32, v0
    s_and_saveexec_b64 s[18:19], vcc
    ds_write_b128 v54, v[50:53] offset:4096
    s_mov_b64 exec, s[18:19]
    s_add_u32 s44, s14, 0x1430000
    s_addc_u32 s45, s15, 0
    s_mov_b32 s46, 0x2000
    s_mov_b32 s47, 0x20000
    s_mov_b32 s50, 0
    s_waitcnt vmcnt(1)
    v_perm_b32 v50, v12, v13, s40
    v_perm_b32 v51, v10, v11, s40
    v_perm_b32 v52, v11, v12, s40
    ds_write_b64 v3, v[50:51] offset:2048
    ds_write_b32 v3, v50 offset:10364
    ds_write_b32 v3, v51 offset:10368
    ds_write_b16 v3, v13 offset:6206
    ds_write_b32 v3, v52 offset:6208
    ds_write_b16 v3, v10 offset:6212
    ds_write_b16 v3, v13 offset:14522
    ds_write_b32 v3, v52 offset:14524
    ds_write_b16 v3, v10 offset:14528
    v_perm_b32 v54, v12, v13, s41
    v_perm_b32 v55, v10, v11, s41
    v_perm_b32 v56, v11, v12, s41
    ds_write_b64 v3, v[54:55] offset:23296
    ds_write_b32 v3, v54 offset:31612
    ds_write_b32 v3, v55 offset:31616
    ds_write_b16_d16_hi v3, v13 offset:27454
    ds_write_b32 v3, v56 offset:27456
    ds_write_b16_d16_hi v3, v10 offset:27460
    ds_write_b16_d16_hi v3, v13 offset:35770
    ds_write_b32 v3, v56 offset:35772
    ds_write_b16_d16_hi v3, v10 offset:35776
    s_waitcnt lgkmcnt(0)
    s_barrier
    s_waitcnt vmcnt(0)
    s_add_u32 s32, s14, 0xc00000
    s_addc_u32 s33, s15, 0
    s_mov_b32 s34, 0x208000
    s_mov_b32 s35, 0x20000
    v_mov_b32 v66, -1
    v_mov_b32 v67, -1
    v_mov_b32 v68, -1
    v_mov_b32 v69, -1
    buffer_store_dwordx4 v[66:69], v2, s[24:27], s84 offen sc1
    buffer_store_dwordx4 v[66:69], v2, s[24:27], s83 offen sc1
    buffer_store_dwordx4 v[66:69], v2, s[32:35], s84 offen sc1
    buffer_store_dwordx4 v[66:69], v2, s[32:35], s83 offen sc1
    v_perm_b32 v50, v16, v17, s40
    v_perm_b32 v51, v14, v15, s40
    v_perm_b32 v52, v15, v16, s40
    ds_write_b64 v3, v[50:51] offset:0
    ds_write_b32 v3, v50 offset:8316
    ds_write_b32 v3, v51 offset:8320
    ds_write_b16 v3, v17 offset:4158
    ds_write_b32 v3, v52 offset:4160
    ds_write_b16 v3, v14 offset:4164
    ds_write_b16 v3, v17 offset:12474
    ds_write_b32 v3, v52 offset:12476
    ds_write_b16 v3, v14 offset:12480
    v_perm_b32 v54, v16, v17, s41
    v_perm_b32 v55, v14, v15, s41
    v_perm_b32 v56, v15, v16, s41
    ds_write_b64 v3, v[54:55] offset:21248
    ds_write_b32 v3, v54 offset:29564
    ds_write_b32 v3, v55 offset:29568
    ds_write_b16_d16_hi v3, v17 offset:25406
    ds_write_b32 v3, v56 offset:25408
    ds_write_b16_d16_hi v3, v14 offset:25412
    ds_write_b16_d16_hi v3, v17 offset:33722
    ds_write_b32 v3, v56 offset:33724
    ds_write_b16_d16_hi v3, v14 offset:33728
    s_waitcnt lgkmcnt(0)
    v_and_b32 v60, 31, v0
    v_mul_u32_u24 v60, 272, v60
    v_lshrrev_b32 v61, 5, v0
    v_lshl_add_u32 v60, v61, 5, v60
    v_add_u32 v60, 63488, v60
    ds_write_b128 v60, v[18:21]
    ds_write_b128 v60, v[22:25] offset:16
    v_lshrrev_b32 v61, 4, v0
    v_and_b32 v62, 15, v0
    v_mul_u32_u24 v63, 272, v61
    v_lshl_add_u32 v63, v62, 4, v63
    v_add_u32 v63, 63488, v63
    s_lshl_b32 s88, s17, 5
    v_add_u32 v61, s88, v61
    s_mov_b32 s88, 8320
    v_mul_lo_u32 v61, v61, s88
    v_lshl_add_u32 v61, v62, 4, v61
    s_and_b32 s88, s3, 31
    s_lshl_b32 s88, s88, 8
    v_add_u32 v61, s88, v61
    s_mov_b32 s89, 133120
    v_mov_b32 v64, 0
    v_mov_b32 v65, 1
    s_waitcnt lgkmcnt(0)
    s_mov_b64 exec, 1
    ds_add_u32 v64, v65 offset:42540
    s_mov_b64 exec, -1
    v_mov_b32 v64, 0
LW_5:
    ds_read_b32 v65, v64 offset:42540
    s_waitcnt lgkmcnt(0)
    v_readfirstlane_b32 s88, v65
    s_cmp_ge_u32 s88, 4
    s_cbranch_scc1 LW_5_d
    s_sleep 1
    s_branch LW_5
LW_5_d:
    ds_read_b128 v[18:21], v63
    ds_read_b128 v[22:25], v63 offset:4352
    s_waitcnt lgkmcnt(0)
    buffer_store_dwordx4 v[18:21], v61, s[56:59], 0 offen sc1
    buffer_store_dwordx4 v[22:25], v61, s[56:59], s89 offen sc1
    v_mov_b32 v94, 0
    v_mov_b32 v95, 1
    s_add_u32 s50, s50, 4
    s_waitcnt vmcnt(0)
    s_mov_b64 exec, 1
    ds_add_rtn_u32 v95, v94, v95 offset:42536
    ds_read_b64 v[92:93], v94 offset:42520
    s_waitcnt lgkmcnt(0)
    v_readfirstlane_b32 s88, v95
    s_add_u32 s88, s88, 1
    s_cmp_lg_u32 s88, s50
    s_cbranch_scc1 H1g0_nf
    s_lshl_b32 s88, s3, 3
    s_add_u32 s88, s88, 0
    v_mov_b32 v94, s88
    buffer_store_dwordx2 v[92:93], v94, s[44:47], 0 offen sc1
H1g0_nf:
    s_mov_b64 exec, -1
    s_barrier
    ds_read_b128 v[50:53], v4 offset:0
    ds_read_b128 v[54:57], v4 offset:5120
    ds_read_b128 v[58:61], v4 offset:10240
    ds_read_b128 v[62:65], v4 offset:15360
    v_lshlrev_b32 v72, 16, v10
    v_lshlrev_b32 v78, 16, v11
    v_lshlrev_b32 v84, 16, v12
    v_lshlrev_b32 v90, 16, v13
    v_and_b32 v73, 0xffff0000, v10
    v_and_b32 v79, 0xffff0000, v11
    v_and_b32 v85, 0xffff0000, v12
    v_and_b32 v91, 0xffff0000, v13
    v_pk_mul_f32 v[72:73], v[72:73], v[6:7]
    v_pk_mul_f32 v[78:79], v[78:79], v[6:7]
    v_pk_mul_f32 v[84:85], v[84:85], v[6:7]
    v_pk_mul_f32 v[90:91], v[90:91], v[6:7]
    v_cvt_pk_bf16_f32 v74, v72, v73
    v_cvt_pk_bf16_f32 v80, v78, v79
    v_cvt_pk_bf16_f32 v86, v84, v85
    v_cvt_pk_bf16_f32 v92, v90, v91
    v_lshlrev_b32 v72, 16, v74
    v_lshlrev_b32 v78, 16, v80
    v_lshlrev_b32 v84, 16, v86
    v_lshlrev_b32 v90, 16, v92
    v_and_b32 v73, 0xffff0000, v74
    v_and_b32 v79, 0xffff0000, v80
    v_and_b32 v85, 0xffff0000, v86
    v_and_b32 v91, 0xffff0000, v92
    s_waitcnt lgkmcnt(0)
    v_add_f32 v70, v50, v54
    v_add_f32 v76, v51, v55
    v_add_f32 v82, v52, v56
    v_add_f32 v88, v53, v57
    v_add_f32 v71, v58, v62
    v_add_f32 v77, v59, v63
    v_add_f32 v83, v60, v64
    v_add_f32 v89, v61, v65
    v_cvt_pk_bf16_f32 v74, v70, v71
    v_cvt_pk_bf16_f32 v80, v76, v77
    v_cvt_pk_bf16_f32 v86, v82, v83
    v_cvt_pk_bf16_f32 v92, v88, v89
    v_lshlrev_b32 v70, 16, v74
    v_lshlrev_b32 v76, 16, v80
    v_lshlrev_b32 v82, 16, v86
    v_lshlrev_b32 v88, 16, v92
    v_and_b32 v71, 0xffff0000, v74
    v_and_b32 v77, 0xffff0000, v80
    v_and_b32 v83, 0xffff0000, v86
    v_and_b32 v89, 0xffff0000, v92
    v_pk_add_f32 v[70:71], v[70:71], v[72:73]
    v_pk_add_f32 v[76:77], v[76:77], v[78:79]
    v_pk_add_f32 v[82:83], v[82:83], v[84:85]
    v_pk_add_f32 v[88:89], v[88:89], v[90:91]
    v_cvt_pk_bf16_f32 v66, v70, v71
    v_cvt_pk_bf16_f32 v67, v76, v77
    v_cvt_pk_bf16_f32 v68, v82, v83
    v_cvt_pk_bf16_f32 v69, v88, v89
    v_min_u32 v66, 0xfffffffe, v66
    v_min_u32 v67, 0xfffffffe, v67
    v_min_u32 v68, 0xfffffffe, v68
    v_min_u32 v69, 0xfffffffe, v69
    buffer_store_dwordx4 v[66:69], v2, s[24:27], s84 offen sc1
    v_mov_b32 v26, v66
    v_mov_b32 v27, v67
    v_mov_b32 v28, v68
    v_mov_b32 v29, v69
    s_barrier
    s_barrier
    ds_read_b128 v[50:53], v4 offset:0
    ds_read_b128 v[54:57], v4 offset:5120
    ds_read_b128 v[58:61], v4 offset:10240
    ds_read_b128 v[62:65], v4 offset:15360
    v_lshlrev_b32 v72, 16, v14
    v_lshlrev_b32 v78, 16, v15
    v_lshlrev_b32 v84, 16, v16
    v_lshlrev_b32 v90, 16, v17
    v_and_b32 v73, 0xffff0000, v14
    v_and_b32 v79, 0xffff0000, v15
    v_and_b32 v85, 0xffff0000, v16
    v_and_b32 v91, 0xffff0000, v17
    v_pk_mul_f32 v[72:73], v[72:73], v[6:7]
    v_pk_mul_f32 v[78:79], v[78:79], v[6:7]
    v_pk_mul_f32 v[84:85], v[84:85], v[6:7]
    v_pk_mul_f32 v[90:91], v[90:91], v[6:7]
    v_cvt_pk_bf16_f32 v74, v72, v73
    v_cvt_pk_bf16_f32 v80, v78, v79
    v_cvt_pk_bf16_f32 v86, v84, v85
    v_cvt_pk_bf16_f32 v92, v90, v91
    v_lshlrev_b32 v72, 16, v74
    v_lshlrev_b32 v78, 16, v80
    v_lshlrev_b32 v84, 16, v86
    v_lshlrev_b32 v90, 16, v92
    v_and_b32 v73, 0xffff0000, v74
    v_and_b32 v79, 0xffff0000, v80
    v_and_b32 v85, 0xffff0000, v86
    v_and_b32 v91, 0xffff0000, v92
    s_waitcnt lgkmcnt(0)
    v_add_f32 v70, v50, v54
    v_add_f32 v76, v51, v55
    v_add_f32 v82, v52, v56
    v_add_f32 v88, v53, v57
    v_add_f32 v71, v58, v62
    v_add_f32 v77, v59, v63
    v_add_f32 v83, v60, v64
    v_add_f32 v89, v61, v65
    v_cvt_pk_bf16_f32 v74, v70, v71
    v_cvt_pk_bf16_f32 v80, v76, v77
    v_cvt_pk_bf16_f32 v86, v82, v83
    v_cvt_pk_bf16_f32 v92, v88, v89
    v_lshlrev_b32 v70, 16, v74
    v_lshlrev_b32 v76, 16, v80
    v_lshlrev_b32 v82, 16, v86
    v_lshlrev_b32 v88, 16, v92
    v_and_b32 v71, 0xffff0000, v74
    v_and_b32 v77, 0xffff0000, v80
    v_and_b32 v83, 0xffff0000, v86
    v_and_b32 v89, 0xffff0000, v92
    v_pk_add_f32 v[70:71], v[70:71], v[72:73]
    v_pk_add_f32 v[76:77], v[76:77], v[78:79]
    v_pk_add_f32 v[82:83], v[82:83], v[84:85]
    v_pk_add_f32 v[88:89], v[88:89], v[90:91]
    v_cvt_pk_bf16_f32 v66, v70, v71
    v_cvt_pk_bf16_f32 v67, v76, v77
    v_cvt_pk_bf16_f32 v68, v82, v83
    v_cvt_pk_bf16_f32 v69, v88, v89
    v_min_u32 v66, 0xfffffffe, v66
    v_min_u32 v67, 0xfffffffe, v67
    v_min_u32 v68, 0xfffffffe, v68
    v_min_u32 v69, 0xfffffffe, v69
    buffer_store_dwordx4 v[66:69], v2, s[24:27], s83 offen sc1
    v_mov_b32 v30, v66
    v_mov_b32 v31, v67
    v_mov_b32 v32, v68
    v_mov_b32 v33, v69
    s_load_dwordx4 s[4:7], s[0:1], 96
    v_lshlrev_b32 v1, 6, v0
    v_mov_b32 v50, s87
    s_lshl_b32 s16, s3, 3
    v_mov_b32 v51, s16
    v_lshlrev_b32 v52, 3, v0
    v_lshlrev_b32 v53, 2, v0
    v_add_u32 v53, 128, v53
    v_min_u32 v52, v52, v53
    v_lshlrev_b32 v53, 1, v0
    v_add_u32 v53, 256, v53
    v_min_u32 v52, v52, v53
    v_add_u32 v53, 384, v0
    v_min_u32 v52, v52, v53
    v_lshlrev_b32 v52, 2, v52
    s_mul_i32 s85, s3, 6144
    s_add_u32 s86, s85, 3072
    s_add_u32 s32, s14, 0x1000000
    s_addc_u32 s33, s15, 0
    s_mov_b32 s34, 0x180000
    s_mov_b32 s35, 0x20000
    s_add_u32 s36, s14, 0x1410000
    s_addc_u32 s37, s15, 0
    s_mov_b32 s38, 0x800
    s_mov_b32 s39, 0x20000
    s_add_u32 s28, s14, 0x1400000
    s_addc_u32 s29, s15, 0
    s_mov_b32 s30, 0x10000
    s_mov_b32 s31, 0x20000
    buffer_load_dwordx4 v[34:37], v52, s[32:35], s85 offen offset:0 sc1
    buffer_load_dwordx4 v[38:41], v52, s[32:35], s85 offen offset:16 sc1
    buffer_load_dwordx4 v[42:45], v52, s[32:35], s86 offen offset:0 sc1
    buffer_load_dwordx4 v[46:49], v52, s[32:35], s86 offen offset:16 sc1
    buffer_load_dwordx2 v[8:9], v51, s[36:39], 0 offen sc1
    s_waitcnt lgkmcnt(0)
    s_mov_b32 s8, s4
    s_mov_b32 s9, s5
    s_mov_b32 s10, 0x400
    s_mov_b32 s11, 0x20000
    s_mov_b32 s60, s6
    s_mov_b32 s61, s7
    s_mov_b32 s62, 0x200000
    s_mov_b32 s63, 0x20000
    buffer_load_dword v5, v50, s[8:11], 0 offen
    s_add_u32 s32, s14, 0xc00000
    s_addc_u32 s33, s15, 0
    s_mov_b32 s34, 0x208000
    s_mov_b32 s35, 0x20000
    s_waitcnt vmcnt(0)
    v_readfirstlane_b32 s88, v0
    s_cmp_ge_u32 s88, 128
    s_cbranch_scc1 PH_seg3
    s_cmp_ge_u32 s88, 64
    s_cbranch_scc1 PH_seg2
    v_cmp_gt_u32 vcc, 32, v0
    s_nop 1
    v_cndmask_b32 v73, v38, v41, vcc
    v_cndmask_b32 v72, v37, v40, vcc
    v_cndmask_b32 v71, v36, v39, vcc
    v_cndmask_b32 v70, v36, v38, vcc
    v_cndmask_b32 v69, v36, v37, vcc
    v_cndmask_b32 v68, v35, v36, vcc
    v_cndmask_b32 v67, v34, v35, vcc
    v_perm_b32 v50, v67, v34, s40
    v_perm_b32 v51, v69, v68, s40
    v_perm_b32 v52, v71, v70, s40
    v_perm_b32 v53, v73, v72, s40
    v_cndmask_b32 v81, v46, v49, vcc
    v_cndmask_b32 v80, v45, v48, vcc
    v_cndmask_b32 v79, v44, v47, vcc
    v_cndmask_b32 v78, v44, v46, vcc
    v_cndmask_b32 v77, v44, v45, vcc
    v_cndmask_b32 v76, v43, v44, vcc
    v_cndmask_b32 v75, v42, v43, vcc
    v_perm_b32 v58, v75, v42, s40
    v_perm_b32 v59, v77, v76, s40
    v_perm_b32 v60, v79, v78, s40
    v_perm_b32 v61, v81, v80, s40
    s_branch PH_segd
PH_seg2:
    v_perm_b32 v50, v34, v34, s40
    v_perm_b32 v51, v35, v34, s40
    v_perm_b32 v52, v35, v35, s40
    v_perm_b32 v53, v36, v36, s40
    v_perm_b32 v58, v42, v42, s40
    v_perm_b32 v59, v43, v42, s40
    v_perm_b32 v60, v43, v43, s40
    v_perm_b32 v61, v44, v44, s40
    s_branch PH_segd
PH_seg3:
    v_and_b32 v66, 1, v0
    v_cmp_eq_u32 vcc, 1, v66
    s_nop 1
    v_cndmask_b32 v68, v34, v35, vcc
    v_perm_b32 v50, v34, v34, s40
    v_perm_b32 v51, v34, v34, s40
    v_perm_b32 v52, v35, v68, s40
    v_perm_b32 v53, v35, v35, s40
    v_cndmask_b32 v69, v42, v43, vcc
    v_perm_b32 v58, v42, v42, s40
    v_perm_b32 v59, v42, v42, s40
    v_perm_b32 v60, v43, v69, s40
    v_perm_b32 v61, v43, v43, s40
PH_segd:
    ds_write_b128 v2, v[50:53] offset:17152
    ds_write_b128 v2, v[58:61] offset:38400
    v_lshlrev_b32 v6, 16, v5
    v_and_b32 v7, 0xffff0000, v5
    v_lshlrev_b32 v5, 12, v0
    s_add_u32 s86, s87, 0x100000
    s_mov_b32 s97, 0
    s_mov_b32 s49, 0
PH_loop:
    s_add_u32 s49, s49, 1
    v_mov_b32 v94, 0
LW_6:
    ds_read_b32 v95, v94 offset:42532
    s_waitcnt lgkmcnt(0)
    v_readfirstlane_b32 s88, v95
    s_cmp_ge_u32 s88, s49
    s_cbranch_scc1 LW_6_d
    s_sleep 1
    s_branch LW_6
LW_6_d:
    s_cmp_eq_u32 s97, 0
    s_cbranch_scc0 PH_nox
    buffer_load_dwordx4 v[18:21], v2, s[56:59], s84 offen sc1
    buffer_load_dwordx4 v[22:25], v2, s[56:59], s83 offen sc1
PH_nox:
    s_sleep 16
    s_lshl_b32 s48, s97, 15
    s_add_u32 s48, s48, 0
    s_mov_b32 s89, 0
PH_poll0:
    buffer_load_dwordx4 v[34:37], v1, s[28:31], s48 offen sc1
    buffer_load_dwordx4 v[38:41], v1, s[28:31], s48 offen offset:16 sc1
    s_waitcnt vmcnt(0)
    v_max3_u32 v94, v34, v35, v36
    v_max3_u32 v95, v37, v38, v39
    v_max3_u32 v94, v94, v40, v41
    v_max_u32 v94, v94, v95
    v_cmp_eq_u32 vcc, -1, v94
    s_add_u32 s89, s89, 1
    s_cbranch_vccz PH_go0
    s_sleep 6
    s_cmp_lt_u32 s89, 1048576
    s_cbranch_scc1 PH_poll0
PH_go0:
    v_lshlrev_b32 v56, 16, v34
    v_lshlrev_b32 v66, 16, v36
    v_lshlrev_b32 v76, 16, v38
    v_lshlrev_b32 v86, 16, v40
    v_and_b32 v58, 0xffff0000, v34
    v_and_b32 v68, 0xffff0000, v36
    v_and_b32 v78, 0xffff0000, v38
    v_and_b32 v88, 0xffff0000, v40
    v_lshlrev_b32 v50, 16, v18
    v_lshlrev_b32 v60, 16, v19
    v_lshlrev_b32 v70, 16, v20
    v_lshlrev_b32 v80, 16, v21
    v_and_b32 v51, 0xffff0000, v18
    v_and_b32 v61, 0xffff0000, v19
    v_and_b32 v71, 0xffff0000, v20
    v_and_b32 v81, 0xffff0000, v21
    v_rcp_f32 v58, v58
    v_rcp_f32 v68, v68
    v_rcp_f32 v78, v78
    v_rcp_f32 v88, v88
    v_pk_add_f32 v[52:53], v[50:51], v[56:57] op_sel_hi:[1,0] neg_lo:[0,1] neg_hi:[0,1]
    v_pk_add_f32 v[62:63], v[60:61], v[66:67] op_sel_hi:[1,0] neg_lo:[0,1] neg_hi:[0,1]
    v_pk_add_f32 v[72:73], v[70:71], v[76:77] op_sel_hi:[1,0] neg_lo:[0,1] neg_hi:[0,1]
    v_pk_add_f32 v[82:83], v[80:81], v[86:87] op_sel_hi:[1,0] neg_lo:[0,1] neg_hi:[0,1]
    v_cvt_pk_bf16_f32 v57, v52, v53
    v_cvt_pk_bf16_f32 v67, v62, v63
    v_cvt_pk_bf16_f32 v77, v72, v73
    v_cvt_pk_bf16_f32 v87, v82, v83
    v_lshlrev_b32 v52, 16, v57
    v_lshlrev_b32 v62, 16, v67
    v_lshlrev_b32 v72, 16, v77
    v_lshlrev_b32 v82, 16, v87
    v_and_b32 v53, 0xffff0000, v57
    v_and_b32 v63, 0xffff0000, v67
    v_and_b32 v73, 0xffff0000, v77
    v_and_b32 v83, 0xffff0000, v87
    v_pk_mul_f32 v[52:53], v[52:53], v[58:59] op_sel_hi:[1,0]
    v_pk_mul_f32 v[62:63], v[62:63], v[68:69] op_sel_hi:[1,0]
    v_pk_mul_f32 v[72:73], v[72:73], v[78:79] op_sel_hi:[1,0]
    v_pk_mul_f32 v[82:83], v[82:83], v[88:89] op_sel_hi:[1,0]
    v_lshlrev_b32 v56, 16, v35
    v_lshlrev_b32 v66, 16, v37
    v_lshlrev_b32 v76, 16, v39
    v_lshlrev_b32 v86, 16, v41
    v_and_b32 v58, 0xffff0000, v35
    v_and_b32 v68, 0xffff0000, v37
    v_and_b32 v78, 0xffff0000, v39
    v_and_b32 v88, 0xffff0000, v41
    v_cvt_pk_bf16_f32 v57, v52, v53
    v_cvt_pk_bf16_f32 v67, v62, v63
    v_cvt_pk_bf16_f32 v77, v72, v73
    v_cvt_pk_bf16_f32 v87, v82, v83
    v_lshlrev_b32 v52, 16, v57
    v_lshlrev_b32 v62, 16, v67
    v_lshlrev_b32 v72, 16, v77
    v_lshlrev_b32 v82, 16, v87
    v_and_b32 v53, 0xffff0000, v57
    v_and_b32 v63, 0xffff0000, v67
    v_and_b32 v73, 0xffff0000, v77
    v_and_b32 v83, 0xffff0000, v87
    v_lshlrev_b32 v54, 16, v26
    v_lshlrev_b32 v64, 16, v27
    v_lshlrev_b32 v74, 16, v28
    v_lshlrev_b32 v84, 16, v29
    v_and_b32 v55, 0xffff0000, v26
    v_and_b32 v65, 0xffff0000, v27
    v_and_b32 v75, 0xffff0000, v28
    v_and_b32 v85, 0xffff0000, v29
    v_rcp_f32 v58, v58
    v_rcp_f32 v68, v68
    v_rcp_f32 v78, v78
    v_rcp_f32 v88, v88
    v_pk_mul_f32 v[52:53], v[52:53], v[54:55]
    v_pk_mul_f32 v[62:63], v[62:63], v[64:65]
    v_pk_mul_f32 v[72:73], v[72:73], v[74:75]
    v_pk_mul_f32 v[82:83], v[82:83], v[84:85]
    v_cvt_pk_bf16_f32 v57, v52, v53
    v_cvt_pk_bf16_f32 v67, v62, v63
    v_cvt_pk_bf16_f32 v77, v72, v73
    v_cvt_pk_bf16_f32 v87, v82, v83
    v_lshlrev_b32 v52, 16, v57
    v_lshlrev_b32 v62, 16, v67
    v_lshlrev_b32 v72, 16, v77
    v_lshlrev_b32 v82, 16, v87
    v_and_b32 v53, 0xffff0000, v57
    v_and_b32 v63, 0xffff0000, v67
    v_and_b32 v73, 0xffff0000, v77
    v_and_b32 v83, 0xffff0000, v87
    v_pk_add_f32 v[50:51], v[50:51], v[52:53]
    v_pk_add_f32 v[60:61], v[60:61], v[62:63]
    v_pk_add_f32 v[70:71], v[70:71], v[72:73]
    v_pk_add_f32 v[80:81], v[80:81], v[82:83]
    v_cvt_pk_bf16_f32 v18, v50, v51
    v_cvt_pk_bf16_f32 v19, v60, v61
    v_cvt_pk_bf16_f32 v20, v70, v71
    v_cvt_pk_bf16_f32 v21, v80, v81
    v_lshlrev_b32 v50, 16, v18
    v_lshlrev_b32 v60, 16, v19
    v_lshlrev_b32 v70, 16, v20
    v_lshlrev_b32 v80, 16, v21
    v_and_b32 v51, 0xffff0000, v18
    v_and_b32 v61, 0xffff0000, v19
    v_and_b32 v71, 0xffff0000, v20
    v_and_b32 v81, 0xffff0000, v21
    v_pk_add_f32 v[52:53], v[50:51], v[56:57] op_sel_hi:[1,0] neg_lo:[0,1] neg_hi:[0,1]
    v_pk_add_f32 v[62:63], v[60:61], v[66:67] op_sel_hi:[1,0] neg_lo:[0,1] neg_hi:[0,1]
    v_pk_add_f32 v[72:73], v[70:71], v[76:77] op_sel_hi:[1,0] neg_lo:[0,1] neg_hi:[0,1]
    v_pk_add_f32 v[82:83], v[80:81], v[86:87] op_sel_hi:[1,0] neg_lo:[0,1] neg_hi:[0,1]
    v_cvt_pk_bf16_f32 v57, v52, v53
    v_cvt_pk_bf16_f32 v67, v62, v63
    v_cvt_pk_bf16_f32 v77, v72, v73
    v_cvt_pk_bf16_f32 v87, v82, v83
    v_lshlrev_b32 v52, 16, v57
    v_lshlrev_b32 v62, 16, v67
    v_lshlrev_b32 v72, 16, v77
    v_lshlrev_b32 v82, 16, v87
    v_and_b32 v53, 0xffff0000, v57
    v_and_b32 v63, 0xffff0000, v67
    v_and_b32 v73, 0xffff0000, v77
    v_and_b32 v83, 0xffff0000, v87
    v_pk_mul_f32 v[52:53], v[52:53], v[58:59] op_sel_hi:[1,0]
    v_pk_mul_f32 v[62:63], v[62:63], v[68:69] op_sel_hi:[1,0]
    v_pk_mul_f32 v[72:73], v[72:73], v[78:79] op_sel_hi:[1,0]
    v_pk_mul_f32 v[82:83], v[82:83], v[88:89] op_sel_hi:[1,0]
    v_cvt_pk_bf16_f32 v10, v52, v53
    v_cvt_pk_bf16_f32 v11, v62, v63
    v_cvt_pk_bf16_f32 v12, v72, v73
    v_cvt_pk_bf16_f32 v13, v82, v83
    v_lshlrev_b32 v52, 16, v10
    v_lshlrev_b32 v62, 16, v11
    v_lshlrev_b32 v72, 16, v12
    v_lshlrev_b32 v82, 16, v13
    v_and_b32 v53, 0xffff0000, v10
    v_and_b32 v63, 0xffff0000, v11
    v_and_b32 v73, 0xffff0000, v12
    v_and_b32 v83, 0xffff0000, v13
    v_cvt_pk_f16_f32 v90, v52, v53
    v_cvt_pk_f16_f32 v91, v62, v63
    v_cvt_pk_f16_f32 v92, v72, v73
    v_cvt_pk_f16_f32 v93, v82, v83
    v_perm_b32 v50, v92, v93, s40
    v_perm_b32 v51, v90, v91, s40
    v_perm_b32 v52, v91, v92, s40
    ds_write_b64 v3, v[50:51] offset:2048
    ds_write_b32 v3, v50 offset:10364
    ds_write_b32 v3, v51 offset:10368
    ds_write_b16 v3, v93 offset:6206
    ds_write_b32 v3, v52 offset:6208
    ds_write_b16 v3, v90 offset:6212
    ds_write_b16 v3, v93 offset:14522
    ds_write_b32 v3, v52 offset:14524
    ds_write_b16 v3, v90 offset:14528
    v_perm_b32 v54, v92, v93, s41
    v_perm_b32 v55, v90, v91, s41
    v_perm_b32 v56, v91, v92, s41
    ds_write_b64 v3, v[54:55] offset:23296
    ds_write_b32 v3, v54 offset:31612
    ds_write_b32 v3, v55 offset:31616
    ds_write_b16_d16_hi v3, v93 offset:27454
    ds_write_b32 v3, v56 offset:27456
    ds_write_b16_d16_hi v3, v90 offset:27460
    ds_write_b16_d16_hi v3, v93 offset:35770
    ds_write_b32 v3, v56 offset:35772
    ds_write_b16_d16_hi v3, v90 offset:35776
    s_waitcnt lgkmcnt(0)
    s_barrier
    s_add_u32 s49, s49, 1
    v_mov_b32 v94, 0
LW_7:
    ds_read_b32 v95, v94 offset:42532
    s_waitcnt lgkmcnt(0)
    v_readfirstlane_b32 s88, v95
    s_cmp_ge_u32 s88, s49
    s_cbranch_scc1 LW_7_d
    s_sleep 1
    s_branch LW_7
LW_7_d:
    s_lshl_b32 s48, s97, 15
    s_add_u32 s48, s48, 16384
    s_mov_b32 s89, 0
PH_poll1:
    buffer_load_dwordx4 v[42:45], v1, s[28:31], s48 offen sc1
    buffer_load_dwordx4 v[46:49], v1, s[28:31], s48 offen offset:16 sc1
    s_waitcnt vmcnt(0)
    v_max3_u32 v94, v42, v43, v44
    v_max3_u32 v95, v45, v46, v47
    v_max3_u32 v94, v94, v48, v49
    v_max_u32 v94, v94, v95
    v_cmp_eq_u32 vcc, -1, v94
    s_add_u32 s89, s89, 1
    s_cbranch_vccz PH_go1
    s_sleep 6
    s_cmp_lt_u32 s89, 1048576
    s_cbranch_scc1 PH_poll1
PH_go1:
    v_lshlrev_b32 v56, 16, v42
    v_lshlrev_b32 v66, 16, v44
    v_lshlrev_b32 v76, 16, v46
    v_lshlrev_b32 v86, 16, v48
    v_and_b32 v58, 0xffff0000, v42
    v_and_b32 v68, 0xffff0000, v44
    v_and_b32 v78, 0xffff0000, v46
    v_and_b32 v88, 0xffff0000, v48
    v_lshlrev_b32 v50, 16, v22
    v_lshlrev_b32 v60, 16, v23
    v_lshlrev_b32 v70, 16, v24
    v_lshlrev_b32 v80, 16, v25
    v_and_b32 v51, 0xffff0000, v22
    v_and_b32 v61, 0xffff0000, v23
    v_and_b32 v71, 0xffff0000, v24
    v_and_b32 v81, 0xffff0000, v25
    v_rcp_f32 v58, v58
    v_rcp_f32 v68, v68
    v_rcp_f32 v78, v78
    v_rcp_f32 v88, v88
    v_pk_add_f32 v[52:53], v[50:51], v[56:57] op_sel_hi:[1,0] neg_lo:[0,1] neg_hi:[0,1]
    v_pk_add_f32 v[62:63], v[60:61], v[66:67] op_sel_hi:[1,0] neg_lo:[0,1] neg_hi:[0,1]
    v_pk_add_f32 v[72:73], v[70:71], v[76:77] op_sel_hi:[1,0] neg_lo:[0,1] neg_hi:[0,1]
    v_pk_add_f32 v[82:83], v[80:81], v[86:87] op_sel_hi:[1,0] neg_lo:[0,1] neg_hi:[0,1]
    v_cvt_pk_bf16_f32 v57, v52, v53
    v_cvt_pk_bf16_f32 v67, v62, v63
    v_cvt_pk_bf16_f32 v77, v72, v73
    v_cvt_pk_bf16_f32 v87, v82, v83
    v_lshlrev_b32 v52, 16, v57
    v_lshlrev_b32 v62, 16, v67
    v_lshlrev_b32 v72, 16, v77
    v_lshlrev_b32 v82, 16, v87
    v_and_b32 v53, 0xffff0000, v57
    v_and_b32 v63, 0xffff0000, v67
    v_and_b32 v73, 0xffff0000, v77
    v_and_b32 v83, 0xffff0000, v87
    v_pk_mul_f32 v[52:53], v[52:53], v[58:59] op_sel_hi:[1,0]
    v_pk_mul_f32 v[62:63], v[62:63], v[68:69] op_sel_hi:[1,0]
    v_pk_mul_f32 v[72:73], v[72:73], v[78:79] op_sel_hi:[1,0]
    v_pk_mul_f32 v[82:83], v[82:83], v[88:89] op_sel_hi:[1,0]
    v_lshlrev_b32 v56, 16, v43
    v_lshlrev_b32 v66, 16, v45
    v_lshlrev_b32 v76, 16, v47
    v_lshlrev_b32 v86, 16, v49
    v_and_b32 v58, 0xffff0000, v43
    v_and_b32 v68, 0xffff0000, v45
    v_and_b32 v78, 0xffff0000, v47
    v_and_b32 v88, 0xffff0000, v49
    v_cvt_pk_bf16_f32 v57, v52, v53
    v_cvt_pk_bf16_f32 v67, v62, v63
    v_cvt_pk_bf16_f32 v77, v72, v73
    v_cvt_pk_bf16_f32 v87, v82, v83
    v_lshlrev_b32 v52, 16, v57
    v_lshlrev_b32 v62, 16, v67
    v_lshlrev_b32 v72, 16, v77
    v_lshlrev_b32 v82, 16, v87
    v_and_b32 v53, 0xffff0000, v57
    v_and_b32 v63, 0xffff0000, v67
    v_and_b32 v73, 0xffff0000, v77
    v_and_b32 v83, 0xffff0000, v87
    v_lshlrev_b32 v54, 16, v30
    v_lshlrev_b32 v64, 16, v31
    v_lshlrev_b32 v74, 16, v32
    v_lshlrev_b32 v84, 16, v33
    v_and_b32 v55, 0xffff0000, v30
    v_and_b32 v65, 0xffff0000, v31
    v_and_b32 v75, 0xffff0000, v32
    v_and_b32 v85, 0xffff0000, v33
    v_rcp_f32 v58, v58
    v_rcp_f32 v68, v68
    v_rcp_f32 v78, v78
    v_rcp_f32 v88, v88
    v_pk_mul_f32 v[52:53], v[52:53], v[54:55]
    v_pk_mul_f32 v[62:63], v[62:63], v[64:65]
    v_pk_mul_f32 v[72:73], v[72:73], v[74:75]
    v_pk_mul_f32 v[82:83], v[82:83], v[84:85]
    v_cvt_pk_bf16_f32 v57, v52, v53
    v_cvt_pk_bf16_f32 v67, v62, v63
    v_cvt_pk_bf16_f32 v77, v72, v73
    v_cvt_pk_bf16_f32 v87, v82, v83
    v_lshlrev_b32 v52, 16, v57
    v_lshlrev_b32 v62, 16, v67
    v_lshlrev_b32 v72, 16, v77
    v_lshlrev_b32 v82, 16, v87
    v_and_b32 v53, 0xffff0000, v57
    v_and_b32 v63, 0xffff0000, v67
    v_and_b32 v73, 0xffff0000, v77
    v_and_b32 v83, 0xffff0000, v87
    v_pk_add_f32 v[50:51], v[50:51], v[52:53]
    v_pk_add_f32 v[60:61], v[60:61], v[62:63]
    v_pk_add_f32 v[70:71], v[70:71], v[72:73]
    v_pk_add_f32 v[80:81], v[80:81], v[82:83]
    v_cvt_pk_bf16_f32 v22, v50, v51
    v_cvt_pk_bf16_f32 v23, v60, v61
    v_cvt_pk_bf16_f32 v24, v70, v71
    v_cvt_pk_bf16_f32 v25, v80, v81
    v_lshlrev_b32 v50, 16, v22
    v_lshlrev_b32 v60, 16, v23
    v_lshlrev_b32 v70, 16, v24
    v_lshlrev_b32 v80, 16, v25
    v_and_b32 v51, 0xffff0000, v22
    v_and_b32 v61, 0xffff0000, v23
    v_and_b32 v71, 0xffff0000, v24
    v_and_b32 v81, 0xffff0000, v25
    v_pk_add_f32 v[52:53], v[50:51], v[56:57] op_sel_hi:[1,0] neg_lo:[0,1] neg_hi:[0,1]
    v_pk_add_f32 v[62:63], v[60:61], v[66:67] op_sel_hi:[1,0] neg_lo:[0,1] neg_hi:[0,1]
    v_pk_add_f32 v[72:73], v[70:71], v[76:77] op_sel_hi:[1,0] neg_lo:[0,1] neg_hi:[0,1]
    v_pk_add_f32 v[82:83], v[80:81], v[86:87] op_sel_hi:[1,0] neg_lo:[0,1] neg_hi:[0,1]
    v_cvt_pk_bf16_f32 v57, v52, v53
    v_cvt_pk_bf16_f32 v67, v62, v63
    v_cvt_pk_bf16_f32 v77, v72, v73
    v_cvt_pk_bf16_f32 v87, v82, v83
    v_lshlrev_b32 v52, 16, v57
    v_lshlrev_b32 v62, 16, v67
    v_lshlrev_b32 v72, 16, v77
    v_lshlrev_b32 v82, 16, v87
    v_and_b32 v53, 0xffff0000, v57
    v_and_b32 v63, 0xffff0000, v67
    v_and_b32 v73, 0xffff0000, v77
    v_and_b32 v83, 0xffff0000, v87
    v_pk_mul_f32 v[52:53], v[52:53], v[58:59] op_sel_hi:[1,0]
    v_pk_mul_f32 v[62:63], v[62:63], v[68:69] op_sel_hi:[1,0]
    v_pk_mul_f32 v[72:73], v[72:73], v[78:79] op_sel_hi:[1,0]
    v_pk_mul_f32 v[82:83], v[82:83], v[88:89] op_sel_hi:[1,0]
    v_cvt_pk_bf16_f32 v14, v52, v53
    v_cvt_pk_bf16_f32 v15, v62, v63
    v_cvt_pk_bf16_f32 v16, v72, v73
    v_cvt_pk_bf16_f32 v17, v82, v83
    v_lshlrev_b32 v52, 16, v14
    v_lshlrev_b32 v62, 16, v15
    v_lshlrev_b32 v72, 16, v16
    v_lshlrev_b32 v82, 16, v17
    v_and_b32 v53, 0xffff0000, v14
    v_and_b32 v63, 0xffff0000, v15
    v_and_b32 v73, 0xffff0000, v16
    v_and_b32 v83, 0xffff0000, v17
    v_cvt_pk_f16_f32 v34, v52, v53
    v_cvt_pk_f16_f32 v35, v62, v63
    v_cvt_pk_f16_f32 v36, v72, v73
    v_cvt_pk_f16_f32 v37, v82, v83
    s_barrier
    ds_read_b128 v[50:53], v4 offset:0
    ds_read_b128 v[54:57], v4 offset:5120
    ds_read_b128 v[58:61], v4 offset:10240
    ds_read_b128 v[62:65], v4 offset:15360
    v_lshlrev_b32 v72, 16, v10
    v_lshlrev_b32 v78, 16, v11
    v_lshlrev_b32 v84, 16, v12
    v_lshlrev_b32 v90, 16, v13
    v_and_b32 v73, 0xffff0000, v10
    v_and_b32 v79, 0xffff0000, v11
    v_and_b32 v85, 0xffff0000, v12
    v_and_b32 v91, 0xffff0000, v13
    v_pk_mul_f32 v[72:73], v[72:73], v[6:7]
    v_pk_mul_f32 v[78:79], v[78:79], v[6:7]
    v_pk_mul_f32 v[84:85], v[84:85], v[6:7]
    v_pk_mul_f32 v[90:91], v[90:91], v[6:7]
    v_cvt_pk_bf16_f32 v74, v72, v73
    v_cvt_pk_bf16_f32 v80, v78, v79
    v_cvt_pk_bf16_f32 v86, v84, v85
    v_cvt_pk_bf16_f32 v92, v90, v91
    v_lshlrev_b32 v72, 16, v74
    v_lshlrev_b32 v78, 16, v80
    v_lshlrev_b32 v84, 16, v86
    v_lshlrev_b32 v90, 16, v92
    v_and_b32 v73, 0xffff0000, v74
    v_and_b32 v79, 0xffff0000, v80
    v_and_b32 v85, 0xffff0000, v86
    v_and_b32 v91, 0xffff0000, v92
    s_waitcnt lgkmcnt(0)
    v_add_f32 v70, v50, v54
    v_add_f32 v76, v51, v55
    v_add_f32 v82, v52, v56
    v_add_f32 v88, v53, v57
    v_add_f32 v71, v58, v62
    v_add_f32 v77, v59, v63
    v_add_f32 v83, v60, v64
    v_add_f32 v89, v61, v65
    v_pk_mul_f32 v[70:71], v[70:71], v[8:9]
    v_pk_mul_f32 v[76:77], v[76:77], v[8:9]
    v_pk_mul_f32 v[82:83], v[82:83], v[8:9]
    v_pk_mul_f32 v[88:89], v[88:89], v[8:9]
    v_cvt_pk_bf16_f32 v74, v70, v71
    v_cvt_pk_bf16_f32 v80, v76, v77
    v_cvt_pk_bf16_f32 v86, v82, v83
    v_cvt_pk_bf16_f32 v92, v88, v89
    v_lshlrev_b32 v70, 16, v74
    v_lshlrev_b32 v76, 16, v80
    v_lshlrev_b32 v82, 16, v86
    v_lshlrev_b32 v88, 16, v92
    v_and_b32 v71, 0xffff0000, v74
    v_and_b32 v77, 0xffff0000, v80
    v_and_b32 v83, 0xffff0000, v86
    v_and_b32 v89, 0xffff0000, v92
    v_pk_add_f32 v[70:71], v[70:71], v[72:73]
    v_pk_add_f32 v[76:77], v[76:77], v[78:79]
    v_pk_add_f32 v[82:83], v[82:83], v[84:85]
    v_pk_add_f32 v[88:89], v[88:89], v[90:91]
    v_cvt_pk_bf16_f32 v74, v70, v71
    v_cvt_pk_bf16_f32 v80, v76, v77
    v_cvt_pk_bf16_f32 v86, v82, v83
    v_cvt_pk_bf16_f32 v92, v88, v89
    v_lshlrev_b32 v70, 16, v74
    v_lshlrev_b32 v76, 16, v80
    v_lshlrev_b32 v82, 16, v86
    v_lshlrev_b32 v88, 16, v92
    v_and_b32 v71, 0xffff0000, v74
    v_and_b32 v77, 0xffff0000, v80
    v_and_b32 v83, 0xffff0000, v86
    v_and_b32 v89, 0xffff0000, v92
    v_lshlrev_b32 v72, 16, v18
    v_lshlrev_b32 v78, 16, v19
    v_lshlrev_b32 v84, 16, v20
    v_lshlrev_b32 v90, 16, v21
    v_and_b32 v73, 0xffff0000, v18
    v_and_b32 v79, 0xffff0000, v19
    v_and_b32 v85, 0xffff0000, v20
    v_and_b32 v91, 0xffff0000, v21
    v_pk_add_f32 v[70:71], v[70:71], v[72:73]
    v_pk_add_f32 v[76:77], v[76:77], v[78:79]
    v_pk_add_f32 v[82:83], v[82:83], v[84:85]
    v_pk_add_f32 v[88:89], v[88:89], v[90:91]
    v_cvt_pk_bf16_f32 v66, v70, v71
    v_cvt_pk_bf16_f32 v67, v76, v77
    v_cvt_pk_bf16_f32 v68, v82, v83
    v_cvt_pk_bf16_f32 v69, v88, v89
    s_cmp_eq_u32 s97, 0
    s_cbranch_scc0 PH_st0
    v_min_u32 v66, 0xfffffffe, v66
    v_min_u32 v67, 0xfffffffe, v67
    v_min_u32 v68, 0xfffffffe, v68
    v_min_u32 v69, 0xfffffffe, v69
    buffer_store_dwordx4 v[66:69], v2, s[32:35], s84 offen sc1
    v_mov_b32 v18, v66
    v_mov_b32 v19, v67
    v_mov_b32 v20, v68
    v_mov_b32 v21, v69
    s_branch PH_sd0
PH_st0:
    buffer_store_dword v66, v5, s[60:63], s87 offen offset:0
    buffer_store_dword v67, v5, s[60:63], s87 offen offset:1024
    buffer_store_dword v68, v5, s[60:63], s87 offen offset:2048
    buffer_store_dword v69, v5, s[60:63], s87 offen offset:3072
PH_sd0:
    s_nop 1
    v_perm_b32 v50, v36, v37, s40
    v_perm_b32 v51, v34, v35, s40
    v_perm_b32 v52, v35, v36, s40
    ds_write_b64 v3, v[50:51] offset:0
    ds_write_b32 v3, v50 offset:8316
    ds_write_b32 v3, v51 offset:8320
    ds_write_b16 v3, v37 offset:4158
    ds_write_b32 v3, v52 offset:4160
    ds_write_b16 v3, v34 offset:4164
    ds_write_b16 v3, v37 offset:12474
    ds_write_b32 v3, v52 offset:12476
    ds_write_b16 v3, v34 offset:12480
    v_perm_b32 v54, v36, v37, s41
    v_perm_b32 v55, v34, v35, s41
    v_perm_b32 v56, v35, v36, s41
    ds_write_b64 v3, v[54:55] offset:21248
    ds_write_b32 v3, v54 offset:29564
    ds_write_b32 v3, v55 offset:29568
    ds_write_b16_d16_hi v3, v37 offset:25406
    ds_write_b32 v3, v56 offset:25408
    ds_write_b16_d16_hi v3, v34 offset:25412
    ds_write_b16_d16_hi v3, v37 offset:33722
    ds_write_b32 v3, v56 offset:33724
    ds_write_b16_d16_hi v3, v34 offset:33728
    s_waitcnt lgkmcnt(0)
    s_barrier
    s_barrier
    ds_read_b128 v[50:53], v4 offset:0
    ds_read_b128 v[54:57], v4 offset:5120
    ds_read_b128 v[58:61], v4 offset:10240
    ds_read_b128 v[62:65], v4 offset:15360
    v_lshlrev_b32 v72, 16, v14
    v_lshlrev_b32 v78, 16, v15
    v_lshlrev_b32 v84, 16, v16
    v_lshlrev_b32 v90, 16, v17
    v_and_b32 v73, 0xffff0000, v14
    v_and_b32 v79, 0xffff0000, v15
    v_and_b32 v85, 0xffff0000, v16
    v_and_b32 v91, 0xffff0000, v17
    v_pk_mul_f32 v[72:73], v[72:73], v[6:7]
    v_pk_mul_f32 v[78:79], v[78:79], v[6:7]
    v_pk_mul_f32 v[84:85], v[84:85], v[6:7]
    v_pk_mul_f32 v[90:91], v[90:91], v[6:7]
    v_cvt_pk_bf16_f32 v74, v72, v73
    v_cvt_pk_bf16_f32 v80, v78, v79
    v_cvt_pk_bf16_f32 v86, v84, v85
    v_cvt_pk_bf16_f32 v92, v90, v91
    v_lshlrev_b32 v72, 16, v74
    v_lshlrev_b32 v78, 16, v80
    v_lshlrev_b32 v84, 16, v86
    v_lshlrev_b32 v90, 16, v92
    v_and_b32 v73, 0xffff0000, v74
    v_and_b32 v79, 0xffff0000, v80
    v_and_b32 v85, 0xffff0000, v86
    v_and_b32 v91, 0xffff0000, v92
    s_waitcnt lgkmcnt(0)
    v_add_f32 v70, v50, v54
    v_add_f32 v76, v51, v55
    v_add_f32 v82, v52, v56
    v_add_f32 v88, v53, v57
    v_add_f32 v71, v58, v62
    v_add_f32 v77, v59, v63
    v_add_f32 v83, v60, v64
    v_add_f32 v89, v61, v65
    v_pk_mul_f32 v[70:71], v[70:71], v[8:9]
    v_pk_mul_f32 v[76:77], v[76:77], v[8:9]
    v_pk_mul_f32 v[82:83], v[82:83], v[8:9]
    v_pk_mul_f32 v[88:89], v[88:89], v[8:9]
    v_cvt_pk_bf16_f32 v74, v70, v71
    v_cvt_pk_bf16_f32 v80, v76, v77
    v_cvt_pk_bf16_f32 v86, v82, v83
    v_cvt_pk_bf16_f32 v92, v88, v89
    v_lshlrev_b32 v70, 16, v74
    v_lshlrev_b32 v76, 16, v80
    v_lshlrev_b32 v82, 16, v86
    v_lshlrev_b32 v88, 16, v92
    v_and_b32 v71, 0xffff0000, v74
    v_and_b32 v77, 0xffff0000, v80
    v_and_b32 v83, 0xffff0000, v86
    v_and_b32 v89, 0xffff0000, v92
    v_pk_add_f32 v[70:71], v[70:71], v[72:73]
    v_pk_add_f32 v[76:77], v[76:77], v[78:79]
    v_pk_add_f32 v[82:83], v[82:83], v[84:85]
    v_pk_add_f32 v[88:89], v[88:89], v[90:91]
    v_cvt_pk_bf16_f32 v74, v70, v71
    v_cvt_pk_bf16_f32 v80, v76, v77
    v_cvt_pk_bf16_f32 v86, v82, v83
    v_cvt_pk_bf16_f32 v92, v88, v89
    v_lshlrev_b32 v70, 16, v74
    v_lshlrev_b32 v76, 16, v80
    v_lshlrev_b32 v82, 16, v86
    v_lshlrev_b32 v88, 16, v92
    v_and_b32 v71, 0xffff0000, v74
    v_and_b32 v77, 0xffff0000, v80
    v_and_b32 v83, 0xffff0000, v86
    v_and_b32 v89, 0xffff0000, v92
    v_lshlrev_b32 v72, 16, v22
    v_lshlrev_b32 v78, 16, v23
    v_lshlrev_b32 v84, 16, v24
    v_lshlrev_b32 v90, 16, v25
    v_and_b32 v73, 0xffff0000, v22
    v_and_b32 v79, 0xffff0000, v23
    v_and_b32 v85, 0xffff0000, v24
    v_and_b32 v91, 0xffff0000, v25
    v_pk_add_f32 v[70:71], v[70:71], v[72:73]
    v_pk_add_f32 v[76:77], v[76:77], v[78:79]
    v_pk_add_f32 v[82:83], v[82:83], v[84:85]
    v_pk_add_f32 v[88:89], v[88:89], v[90:91]
    v_cvt_pk_bf16_f32 v66, v70, v71
    v_cvt_pk_bf16_f32 v67, v76, v77
    v_cvt_pk_bf16_f32 v68, v82, v83
    v_cvt_pk_bf16_f32 v69, v88, v89
    s_cmp_eq_u32 s97, 0
    s_cbranch_scc0 PH_st1
    v_min_u32 v66, 0xfffffffe, v66
    v_min_u32 v67, 0xfffffffe, v67
    v_min_u32 v68, 0xfffffffe, v68
    v_min_u32 v69, 0xfffffffe, v69
    buffer_store_dwordx4 v[66:69], v2, s[32:35], s83 offen sc1
    v_mov_b32 v22, v66
    v_mov_b32 v23, v67
    v_mov_b32 v24, v68
    v_mov_b32 v25, v69
    s_branch PH_sd1
PH_st1:
    buffer_store_dword v66, v5, s[60:63], s86 offen offset:0
    buffer_store_dword v67, v5, s[60:63], s86 offen offset:1024
    buffer_store_dword v68, v5, s[60:63], s86 offen offset:2048
    buffer_store_dword v69, v5, s[60:63], s86 offen offset:3072
PH_sd1:
    s_nop 1
    s_add_u32 s97, s97, 1
    s_cmp_lt_u32 s97, 2
    s_cbranch_scc1 PH_loop
F1_done:
    s_endpgm
CODE_END:
.section .rodata,"a"
.p2align 6
.amdhsa_kernel p_kernel
  .amdhsa_next_free_vgpr 128
  .amdhsa_next_free_sgpr 100
  .amdhsa_accum_offset 96
  .amdhsa_group_segment_fixed_size 0
  .amdhsa_kernarg_size 128
  .amdhsa_user_sgpr_count 2
  .amdhsa_user_sgpr_kernarg_segment_ptr 1
  .amdhsa_system_sgpr_workgroup_id_x 1
  .amdhsa_float_denorm_mode_32 3
.end_amdhsa_kernel
```
